```python
import torch

def _softmax(x, axis=-1):
    return torch.softmax(x, dim=axis)
def _gelu(x):
    return torch.nn.functional.gelu(x, approximate="tanh")
def _silu(x):
    return torch.nn.functional.silu(x)
def _sigmoid(x):
    return torch.sigmoid(x)
def _layernorm(x, axis=-1, eps=1e-5):
    m = x.mean(dim=axis, keepdim=True)
    v = x.var(dim=axis, keepdim=True, unbiased=False)
    return (x - m) / torch.sqrt(v + eps)
def _scatter_add(tgt, idx, src, axis=0):
    return tgt.clone().index_add_(axis, idx, src)
def _segment_sum(src, seg, n):
    out = torch.zeros((n,) + src.shape[1:], dtype=src.dtype)
    return out.index_add_(0, seg, src)
def _pad(x, pw):
    flat = tuple(v for pair in reversed(pw) for v in pair)
    return torch.nn.functional.pad(x, flat)

kernel_name = 'parallel_sum__sliding_block__mixer_token_mlp__prompt'

def setup_inputs():

    _w = (lambda a: (lambda t: t.to(torch.bfloat16) if t.is_floating_point() else t)(torch.as_tensor(a)))
    def _A_setup():
        B, S, D = 1, 2048, 576
        return {
            "x": _w((lambda *s: torch.randn(*s, dtype=torch.bfloat16) * 0.05)(B, S, D)),
            "wqkv": _w((lambda *s: torch.randn(*s, dtype=torch.bfloat16) * 0.05)(D, 3 * D)),
            "wo": _w((lambda *s: torch.randn(*s, dtype=torch.bfloat16) * 0.05)(D, D)),
        }
    _A_in = _A_setup()

    def _B_setup():
        B, S, D, F = 1, 2048, 576, 4608
        return {
            "x": _w((lambda *s: torch.randn(*s, dtype=torch.bfloat16) * 0.05)(B, S, D)),
            "w1": _w((lambda *s: torch.randn(*s, dtype=torch.bfloat16) * 1.6)(S, F) * (S ** -0.5)),
            "b1": _w((lambda *s: torch.randn(*s, dtype=torch.bfloat16) * 12.8)(F) * 0.02),
            "w2": _w((lambda *s: torch.randn(*s, dtype=torch.bfloat16) * 0.4)(F, S) * (F ** -0.5)),
            "b2": _w((lambda *s: torch.randn(*s, dtype=torch.bfloat16) * 6.4)(S) * 0.02),
        }
    _B_in = _B_setup()

    return {
        "A_x": _A_in["x"],
        "A_wqkv": _A_in["wqkv"],
        "A_wo": _A_in["wo"],
        "B_x": _B_in["x"],
        "B_w1": _B_in["w1"],
        "B_b1": _B_in["b1"],
        "B_w2": _B_in["w2"],
        "B_b2": _B_in["b2"],
    }

def reference(A_x, A_wqkv, A_wo, B_x, B_w1, B_b1, B_w2, B_b2):
    def _A_ref(x, wqkv, wo):
        B, S, D = x.shape
        H = 32; Dh = D // H; W = 256
        qkv = (lambda x, *d: x.permute(*d))((x @ wqkv).reshape(B, S, 3, H, Dh), 2, 0, 3, 1, 4)
        q, k, v = qkv[0], qkv[1], qkv[2]
        scores = torch.einsum("bhqd,bhkd->bhqk", q, k) * (Dh ** -0.5)
        idx = torch.arange(S)
        mask = (idx[:, None] - idx[None, :] >= 0) & (idx[:, None] - idx[None, :] < W)
        scores = torch.where(mask[None, None], scores, -1e9)
        p = _softmax(scores, axis=-1)
        o = torch.einsum("bhqk,bhkd->bhqd", p, v)
        return (lambda x, *d: x.permute(*d))(o, 0, 2, 1, 3).reshape(B, S, D) @ wo

    def _B_ref(x, w1, b1, w2, b2):
        B, S, D = x.shape
        h = _layernorm(x, axis=-1)
        u = torch.einsum("bsd,sf->bdf", h, w1) + b1
        u = _gelu(u)
        y = torch.einsum("bdf,fs->bds", u, w2) + b2
        return (lambda x, *d: x.permute(*d))(y, 0, 2, 1)

    x = A_x
    xn = _layernorm(x, axis=-1)
    return x + _A_ref(xn, A_wqkv, A_wo) + _B_ref(xn, B_w1, B_b1, B_w2, B_b2)
```

```asm
; @launch kernel=k0_kernel grid=(254,1,1) block=(512,1,1) lds=38400
; @launch kernel=k1_kernel grid=(256,1,1) block=(512,1,1) lds=122880
; @launch kernel=k2_kernel grid=(256,1,1) block=(512,1,1) lds=122880
; @launch kernel=k3_kernel grid=(192,1,1) block=(256,1,1) lds=83968
.amdgcn_target "amdgcn-amd-amdhsa--gfx950"
.text
  .globl k0_kernel
  .p2align 8
  .type k0_kernel,@function
k0_kernel:
  s_cmp_ge_u32 s2, 254
  s_cbranch_scc1 L0_end
  s_load_dwordx4 s[4:7], s[0:1], 0
  s_load_dwordx2 s[8:9], s[0:1], 80
  s_load_dwordx2 s[10:11], s[0:1], 16
  s_load_dwordx2 s[28:29], s[0:1], 32
  s_load_dwordx2 s[54:55], s[0:1], 48
  s_cmp_ge_u32 s2, 128
  s_cbranch_scc1 L0_wprep
  s_lshl_b32 s3, s2, 4
  v_lshrrev_b32 v2, 5, v0
  v_add_u32 v3, s3, v2
  v_mul_u32_u24 v1, 1152, v3
  v_and_b32 v4, 31, v0
  v_lshl_add_u32 v1, v4, 2, v1
  s_waitcnt lgkmcnt(0)
  s_mov_b32 s12, s4
  s_mov_b32 s13, s5
  s_mov_b32 s14, 2359296
  s_mov_b32 s15, 0x20000
  buffer_load_dword v10, v1, s[12:15], 0 offen offset:0
  buffer_load_dword v11, v1, s[12:15], 0 offen offset:128
  buffer_load_dword v12, v1, s[12:15], 0 offen offset:256
  buffer_load_dword v13, v1, s[12:15], 0 offen offset:384
  buffer_load_dword v14, v1, s[12:15], 0 offen offset:512
  buffer_load_dword v15, v1, s[12:15], 0 offen offset:640
  buffer_load_dword v16, v1, s[12:15], 0 offen offset:768
  buffer_load_dword v17, v1, s[12:15], 0 offen offset:896
  buffer_load_dword v18, v1, s[12:15], 0 offen offset:1024
  s_mov_b32 s48, s28
  s_mov_b32 s49, s29
  s_mov_b32 s50, 18874368
  s_mov_b32 s51, 0x20000
  s_mov_b32 s16, s8
  s_mov_b32 s17, s9
  s_mov_b32 s18, 2359296
  s_mov_b32 s19, 0x20000
  s_add_u32 s20, s8, 3145728
  s_addc_u32 s21, s9, 0
  s_mov_b32 s22, 2359296
  s_mov_b32 s23, 0x20000
  v_mul_u32_u24 v5, 1168, v2
  v_lshl_add_u32 v5, v4, 2, v5
  s_mul_i32 s30, s2, 4608
  v_add_u32 v6, 0, v0
  v_mul_u32_u24 v7, 14564, v6
  v_lshrrev_b32 v7, 18, v7
  v_mul_u32_u24 v8, 18, v7
  v_sub_u32 v8, v6, v8
  v_lshrrev_b32 v9, 4, v7
  v_and_b32 v7, 15, v7
  v_mul_u32_u24 v7, 1168, v7
  v_lshl_add_u32 v7, v8, 4, v7
  v_mul_u32_u24 v8, 288, v9
  v_add_u32 v84, v7, v8
  v_mul_u32_u24 v9, 585216, v9
  v_lshl_add_u32 v87, v6, 4, v9
  v_add_u32 v6, 512, v0
  v_mul_u32_u24 v7, 14564, v6
  v_lshrrev_b32 v7, 18, v7
  v_mul_u32_u24 v8, 18, v7
  v_sub_u32 v8, v6, v8
  v_lshrrev_b32 v9, 4, v7
  v_and_b32 v7, 15, v7
  v_mul_u32_u24 v7, 1168, v7
  v_lshl_add_u32 v7, v8, 4, v7
  v_mul_u32_u24 v8, 288, v9
  v_add_u32 v85, v7, v8
  v_mul_u32_u24 v9, 585216, v9
  v_lshl_add_u32 v88, v6, 4, v9
  v_add_u32 v6, 1024, v0
  v_mul_u32_u24 v7, 14564, v6
  v_lshrrev_b32 v7, 18, v7
  v_mul_u32_u24 v8, 18, v7
  v_sub_u32 v8, v6, v8
  v_lshrrev_b32 v9, 4, v7
  v_and_b32 v7, 15, v7
  v_mul_u32_u24 v7, 1168, v7
  v_lshl_add_u32 v7, v8, 4, v7
  v_mul_u32_u24 v8, 288, v9
  v_add_u32 v86, v7, v8
  v_mul_u32_u24 v9, 585216, v9
  v_lshl_add_u32 v89, v6, 4, v9
  v_and_b32 v93, 15, v0
  v_mul_u32_u24 v91, 1168, v93
  v_lshrrev_b32 v93, 4, v0
  v_lshl_add_u32 v91, v93, 4, v91
  s_mul_i32 s33, s2, 18432
  v_lshl_add_u32 v92, v0, 4, s33
  s_waitcnt vmcnt(8)
  v_lshlrev_b32 v20, 16, v10
  v_and_b32 v21, 0xffff0000, v10
  s_waitcnt vmcnt(7)
  v_lshlrev_b32 v22, 16, v11
  v_and_b32 v23, 0xffff0000, v11
  s_waitcnt vmcnt(6)
  v_lshlrev_b32 v24, 16, v12
  v_and_b32 v25, 0xffff0000, v12
  s_waitcnt vmcnt(5)
  v_lshlrev_b32 v26, 16, v13
  v_and_b32 v27, 0xffff0000, v13
  s_waitcnt vmcnt(4)
  v_lshlrev_b32 v28, 16, v14
  v_and_b32 v29, 0xffff0000, v14
  s_waitcnt vmcnt(3)
  v_lshlrev_b32 v30, 16, v15
  v_and_b32 v31, 0xffff0000, v15
  s_waitcnt vmcnt(2)
  v_lshlrev_b32 v32, 16, v16
  v_and_b32 v33, 0xffff0000, v16
  s_waitcnt vmcnt(1)
  v_lshlrev_b32 v34, 16, v17
  v_and_b32 v35, 0xffff0000, v17
  s_waitcnt vmcnt(0)
  v_lshlrev_b32 v36, 16, v18
  v_and_b32 v37, 0xffff0000, v18
  v_pk_add_f32 v[60:61], v[20:21], v[22:23]
  v_pk_add_f32 v[62:63], v[24:25], v[26:27]
  v_pk_add_f32 v[60:61], v[60:61], v[28:29]
  v_pk_add_f32 v[62:63], v[62:63], v[30:31]
  v_pk_add_f32 v[60:61], v[60:61], v[32:33]
  v_pk_add_f32 v[62:63], v[62:63], v[34:35]
  v_pk_add_f32 v[60:61], v[60:61], v[36:37]
  v_pk_add_f32 v[60:61], v[60:61], v[62:63]
  v_add_f32 v64, v60, v61
  s_nop 1
  v_add_f32_dpp v64, v64, v64 row_ror:8 row_mask:0xf bank_mask:0xf
  s_nop 1
  v_add_f32_dpp v64, v64, v64 row_ror:4 row_mask:0xf bank_mask:0xf
  s_nop 1
  v_add_f32_dpp v64, v64, v64 row_ror:2 row_mask:0xf bank_mask:0xf
  s_nop 1
  v_add_f32_dpp v64, v64, v64 row_ror:1 row_mask:0xf bank_mask:0xf
  v_mov_b32 v68, v64
  s_nop 1
  v_permlane16_swap_b32 v64, v68
  s_nop 1
  v_add_f32 v64, v64, v68
  v_mul_f32 v64, 0x3ae38e39, v64
  v_pk_add_f32 v[40:41], v[20:21], v[64:65] op_sel_hi:[1,0] neg_lo:[0,1] neg_hi:[0,1]
  v_pk_add_f32 v[42:43], v[22:23], v[64:65] op_sel_hi:[1,0] neg_lo:[0,1] neg_hi:[0,1]
  v_pk_add_f32 v[44:45], v[24:25], v[64:65] op_sel_hi:[1,0] neg_lo:[0,1] neg_hi:[0,1]
  v_pk_add_f32 v[46:47], v[26:27], v[64:65] op_sel_hi:[1,0] neg_lo:[0,1] neg_hi:[0,1]
  v_pk_add_f32 v[48:49], v[28:29], v[64:65] op_sel_hi:[1,0] neg_lo:[0,1] neg_hi:[0,1]
  v_pk_add_f32 v[50:51], v[30:31], v[64:65] op_sel_hi:[1,0] neg_lo:[0,1] neg_hi:[0,1]
  v_pk_add_f32 v[52:53], v[32:33], v[64:65] op_sel_hi:[1,0] neg_lo:[0,1] neg_hi:[0,1]
  v_pk_add_f32 v[54:55], v[34:35], v[64:65] op_sel_hi:[1,0] neg_lo:[0,1] neg_hi:[0,1]
  v_pk_add_f32 v[56:57], v[36:37], v[64:65] op_sel_hi:[1,0] neg_lo:[0,1] neg_hi:[0,1]
  v_pk_mul_f32 v[60:61], v[40:41], v[40:41]
  v_pk_mul_f32 v[62:63], v[42:43], v[42:43]
  v_pk_fma_f32 v[60:61], v[44:45], v[44:45], v[60:61]
  v_pk_fma_f32 v[62:63], v[46:47], v[46:47], v[62:63]
  v_pk_fma_f32 v[60:61], v[48:49], v[48:49], v[60:61]
  v_pk_fma_f32 v[62:63], v[50:51], v[50:51], v[62:63]
  v_pk_fma_f32 v[60:61], v[52:53], v[52:53], v[60:61]
  v_pk_fma_f32 v[62:63], v[54:55], v[54:55], v[62:63]
  v_pk_fma_f32 v[60:61], v[56:57], v[56:57], v[60:61]
  v_pk_add_f32 v[60:61], v[60:61], v[62:63]
  v_add_f32 v66, v60, v61
  v_cvt_pk_bf16_f32 v64, v64, v64
  v_lshlrev_b32 v64, 16, v64
  s_nop 1
  v_add_f32_dpp v66, v66, v66 row_ror:8 row_mask:0xf bank_mask:0xf
  s_nop 1
  v_add_f32_dpp v66, v66, v66 row_ror:4 row_mask:0xf bank_mask:0xf
  s_nop 1
  v_add_f32_dpp v66, v66, v66 row_ror:2 row_mask:0xf bank_mask:0xf
  s_nop 1
  v_add_f32_dpp v66, v66, v66 row_ror:1 row_mask:0xf bank_mask:0xf
  v_mov_b32 v68, v66
  s_nop 1
  v_permlane16_swap_b32 v66, v68
  s_nop 1
  v_add_f32 v66, v66, v68
  v_pk_add_f32 v[40:41], v[20:21], v[64:65] op_sel_hi:[1,0] neg_lo:[0,1] neg_hi:[0,1]
  v_pk_add_f32 v[42:43], v[22:23], v[64:65] op_sel_hi:[1,0] neg_lo:[0,1] neg_hi:[0,1]
  v_pk_add_f32 v[44:45], v[24:25], v[64:65] op_sel_hi:[1,0] neg_lo:[0,1] neg_hi:[0,1]
  v_pk_add_f32 v[46:47], v[26:27], v[64:65] op_sel_hi:[1,0] neg_lo:[0,1] neg_hi:[0,1]
  v_pk_add_f32 v[48:49], v[28:29], v[64:65] op_sel_hi:[1,0] neg_lo:[0,1] neg_hi:[0,1]
  v_pk_add_f32 v[50:51], v[30:31], v[64:65] op_sel_hi:[1,0] neg_lo:[0,1] neg_hi:[0,1]
  v_pk_add_f32 v[52:53], v[32:33], v[64:65] op_sel_hi:[1,0] neg_lo:[0,1] neg_hi:[0,1]
  v_pk_add_f32 v[54:55], v[34:35], v[64:65] op_sel_hi:[1,0] neg_lo:[0,1] neg_hi:[0,1]
  v_pk_add_f32 v[56:57], v[36:37], v[64:65] op_sel_hi:[1,0] neg_lo:[0,1] neg_hi:[0,1]
  v_mul_f32 v66, 0x3ae38e39, v66
  v_cvt_pk_bf16_f32 v66, v66, v66
  v_lshlrev_b32 v66, 16, v66
  v_add_f32 v66, 0x3727c5ac, v66
  v_cvt_pk_bf16_f32 v66, v66, v66
  v_lshlrev_b32 v66, 16, v66
  v_sqrt_f32 v66, v66
  v_cvt_pk_bf16_f32 v10, v40, v41
  v_cvt_pk_bf16_f32 v11, v42, v43
  v_cvt_pk_bf16_f32 v12, v44, v45
  v_cvt_pk_bf16_f32 v13, v46, v47
  v_cvt_pk_bf16_f32 v14, v48, v49
  v_cvt_pk_bf16_f32 v15, v50, v51
  v_cvt_pk_bf16_f32 v16, v52, v53
  v_cvt_pk_bf16_f32 v17, v54, v55
  v_cvt_pk_bf16_f32 v18, v56, v57
  v_cvt_pk_bf16_f32 v66, v66, v66
  v_lshlrev_b32 v66, 16, v66
  v_rcp_f32 v66, v66
  v_lshlrev_b32 v40, 16, v10
  v_and_b32 v41, 0xffff0000, v10
  v_lshlrev_b32 v42, 16, v11
  v_and_b32 v43, 0xffff0000, v11
  v_lshlrev_b32 v44, 16, v12
  v_and_b32 v45, 0xffff0000, v12
  v_lshlrev_b32 v46, 16, v13
  v_and_b32 v47, 0xffff0000, v13
  v_lshlrev_b32 v48, 16, v14
  v_and_b32 v49, 0xffff0000, v14
  v_lshlrev_b32 v50, 16, v15
  v_and_b32 v51, 0xffff0000, v15
  v_lshlrev_b32 v52, 16, v16
  v_and_b32 v53, 0xffff0000, v16
  v_lshlrev_b32 v54, 16, v17
  v_and_b32 v55, 0xffff0000, v17
  v_lshlrev_b32 v56, 16, v18
  v_and_b32 v57, 0xffff0000, v18
  v_pk_mul_f32 v[40:41], v[40:41], v[66:67] op_sel_hi:[1,0]
  v_pk_mul_f32 v[42:43], v[42:43], v[66:67] op_sel_hi:[1,0]
  v_pk_mul_f32 v[44:45], v[44:45], v[66:67] op_sel_hi:[1,0]
  v_pk_mul_f32 v[46:47], v[46:47], v[66:67] op_sel_hi:[1,0]
  v_pk_mul_f32 v[48:49], v[48:49], v[66:67] op_sel_hi:[1,0]
  v_pk_mul_f32 v[50:51], v[50:51], v[66:67] op_sel_hi:[1,0]
  v_pk_mul_f32 v[52:53], v[52:53], v[66:67] op_sel_hi:[1,0]
  v_pk_mul_f32 v[54:55], v[54:55], v[66:67] op_sel_hi:[1,0]
  v_pk_mul_f32 v[56:57], v[56:57], v[66:67] op_sel_hi:[1,0]
  v_cvt_pk_bf16_f32 v10, v40, v41
  v_cvt_pk_bf16_f32 v11, v42, v43
  v_cvt_pk_bf16_f32 v12, v44, v45
  v_cvt_pk_bf16_f32 v13, v46, v47
  v_cvt_pk_bf16_f32 v14, v48, v49
  v_cvt_pk_bf16_f32 v15, v50, v51
  v_cvt_pk_bf16_f32 v16, v52, v53
  v_cvt_pk_bf16_f32 v17, v54, v55
  v_cvt_pk_bf16_f32 v18, v56, v57
  ds_write_b32 v5, v10 offset:0
  ds_write_b32 v5, v11 offset:128
  ds_write_b32 v5, v12 offset:256
  ds_write_b32 v5, v13 offset:384
  ds_write_b32 v5, v14 offset:512
  ds_write_b32 v5, v15 offset:640
  ds_write_b32 v5, v16 offset:768
  ds_write_b32 v5, v17 offset:896
  ds_write_b32 v5, v18 offset:1024
  v_lshlrev_b32 v20, 16, v10
  v_and_b32 v21, 0xffff0000, v10
  v_lshlrev_b32 v22, 16, v11
  v_and_b32 v23, 0xffff0000, v11
  v_lshlrev_b32 v24, 16, v12
  v_and_b32 v25, 0xffff0000, v12
  v_lshlrev_b32 v26, 16, v13
  v_and_b32 v27, 0xffff0000, v13
  v_lshlrev_b32 v28, 16, v14
  v_and_b32 v29, 0xffff0000, v14
  v_lshlrev_b32 v30, 16, v15
  v_and_b32 v31, 0xffff0000, v15
  v_lshlrev_b32 v32, 16, v16
  v_and_b32 v33, 0xffff0000, v16
  v_lshlrev_b32 v34, 16, v17
  v_and_b32 v35, 0xffff0000, v17
  v_lshlrev_b32 v36, 16, v18
  v_and_b32 v37, 0xffff0000, v18
  s_waitcnt lgkmcnt(0)
  s_barrier
  ds_read_b128 v[96:99], v91
  ds_read_b128 v[100:103], v91 offset:512
  ds_read_b128 v[104:107], v91 offset:1024
  v_pk_add_f32 v[60:61], v[20:21], v[22:23]
  v_pk_add_f32 v[62:63], v[24:25], v[26:27]
  v_pk_add_f32 v[60:61], v[60:61], v[28:29]
  v_pk_add_f32 v[62:63], v[62:63], v[30:31]
  v_pk_add_f32 v[60:61], v[60:61], v[32:33]
  v_pk_add_f32 v[62:63], v[62:63], v[34:35]
  v_pk_add_f32 v[60:61], v[60:61], v[36:37]
  v_pk_add_f32 v[60:61], v[60:61], v[62:63]
  v_add_f32 v64, v60, v61
  s_nop 1
  v_add_f32_dpp v64, v64, v64 row_ror:8 row_mask:0xf bank_mask:0xf
  s_nop 1
  v_add_f32_dpp v64, v64, v64 row_ror:4 row_mask:0xf bank_mask:0xf
  s_nop 1
  v_add_f32_dpp v64, v64, v64 row_ror:2 row_mask:0xf bank_mask:0xf
  s_nop 1
  v_add_f32_dpp v64, v64, v64 row_ror:1 row_mask:0xf bank_mask:0xf
  v_mov_b32 v68, v64
  s_nop 1
  v_permlane16_swap_b32 v64, v68
  s_nop 1
  v_add_f32 v64, v64, v68
  v_mul_f32 v64, 0x3ae38e39, v64
  v_pk_add_f32 v[40:41], v[20:21], v[64:65] op_sel_hi:[1,0] neg_lo:[0,1] neg_hi:[0,1]
  v_pk_add_f32 v[42:43], v[22:23], v[64:65] op_sel_hi:[1,0] neg_lo:[0,1] neg_hi:[0,1]
  v_pk_add_f32 v[44:45], v[24:25], v[64:65] op_sel_hi:[1,0] neg_lo:[0,1] neg_hi:[0,1]
  v_pk_add_f32 v[46:47], v[26:27], v[64:65] op_sel_hi:[1,0] neg_lo:[0,1] neg_hi:[0,1]
  v_pk_add_f32 v[48:49], v[28:29], v[64:65] op_sel_hi:[1,0] neg_lo:[0,1] neg_hi:[0,1]
  v_pk_add_f32 v[50:51], v[30:31], v[64:65] op_sel_hi:[1,0] neg_lo:[0,1] neg_hi:[0,1]
  v_pk_add_f32 v[52:53], v[32:33], v[64:65] op_sel_hi:[1,0] neg_lo:[0,1] neg_hi:[0,1]
  v_pk_add_f32 v[54:55], v[34:35], v[64:65] op_sel_hi:[1,0] neg_lo:[0,1] neg_hi:[0,1]
  v_pk_add_f32 v[56:57], v[36:37], v[64:65] op_sel_hi:[1,0] neg_lo:[0,1] neg_hi:[0,1]
  v_pk_mul_f32 v[60:61], v[40:41], v[40:41]
  v_pk_mul_f32 v[62:63], v[42:43], v[42:43]
  v_pk_fma_f32 v[60:61], v[44:45], v[44:45], v[60:61]
  v_pk_fma_f32 v[62:63], v[46:47], v[46:47], v[62:63]
  v_pk_fma_f32 v[60:61], v[48:49], v[48:49], v[60:61]
  v_pk_fma_f32 v[62:63], v[50:51], v[50:51], v[62:63]
  v_pk_fma_f32 v[60:61], v[52:53], v[52:53], v[60:61]
  v_pk_fma_f32 v[62:63], v[54:55], v[54:55], v[62:63]
  v_pk_fma_f32 v[60:61], v[56:57], v[56:57], v[60:61]
  v_pk_add_f32 v[60:61], v[60:61], v[62:63]
  v_add_f32 v66, v60, v61
  v_cvt_pk_bf16_f32 v64, v64, v64
  v_lshlrev_b32 v64, 16, v64
  s_nop 1
  v_add_f32_dpp v66, v66, v66 row_ror:8 row_mask:0xf bank_mask:0xf
  s_nop 1
  v_add_f32_dpp v66, v66, v66 row_ror:4 row_mask:0xf bank_mask:0xf
  s_nop 1
  v_add_f32_dpp v66, v66, v66 row_ror:2 row_mask:0xf bank_mask:0xf
  s_nop 1
  v_add_f32_dpp v66, v66, v66 row_ror:1 row_mask:0xf bank_mask:0xf
  v_mov_b32 v68, v66
  s_nop 1
  v_permlane16_swap_b32 v66, v68
  s_nop 1
  v_add_f32 v66, v66, v68
  v_pk_add_f32 v[40:41], v[20:21], v[64:65] op_sel_hi:[1,0] neg_lo:[0,1] neg_hi:[0,1]
  v_pk_add_f32 v[42:43], v[22:23], v[64:65] op_sel_hi:[1,0] neg_lo:[0,1] neg_hi:[0,1]
  v_pk_add_f32 v[44:45], v[24:25], v[64:65] op_sel_hi:[1,0] neg_lo:[0,1] neg_hi:[0,1]
  v_pk_add_f32 v[46:47], v[26:27], v[64:65] op_sel_hi:[1,0] neg_lo:[0,1] neg_hi:[0,1]
  v_pk_add_f32 v[48:49], v[28:29], v[64:65] op_sel_hi:[1,0] neg_lo:[0,1] neg_hi:[0,1]
  v_pk_add_f32 v[50:51], v[30:31], v[64:65] op_sel_hi:[1,0] neg_lo:[0,1] neg_hi:[0,1]
  v_pk_add_f32 v[52:53], v[32:33], v[64:65] op_sel_hi:[1,0] neg_lo:[0,1] neg_hi:[0,1]
  v_pk_add_f32 v[54:55], v[34:35], v[64:65] op_sel_hi:[1,0] neg_lo:[0,1] neg_hi:[0,1]
  v_pk_add_f32 v[56:57], v[36:37], v[64:65] op_sel_hi:[1,0] neg_lo:[0,1] neg_hi:[0,1]
  v_mul_f32 v66, 0x3ae38e39, v66
  v_cvt_pk_bf16_f32 v66, v66, v66
  v_lshlrev_b32 v66, 16, v66
  v_add_f32 v66, 0x3727c5ac, v66
  v_cvt_pk_bf16_f32 v66, v66, v66
  v_lshlrev_b32 v66, 16, v66
  v_sqrt_f32 v66, v66
  v_cvt_pk_bf16_f32 v72, v40, v41
  v_cvt_pk_bf16_f32 v73, v42, v43
  v_cvt_pk_bf16_f32 v74, v44, v45
  v_cvt_pk_bf16_f32 v75, v46, v47
  v_cvt_pk_bf16_f32 v76, v48, v49
  v_cvt_pk_bf16_f32 v77, v50, v51
  v_cvt_pk_bf16_f32 v78, v52, v53
  v_cvt_pk_bf16_f32 v79, v54, v55
  v_cvt_pk_bf16_f32 v80, v56, v57
  v_cvt_pk_bf16_f32 v66, v66, v66
  v_lshlrev_b32 v66, 16, v66
  v_rcp_f32 v66, v66
  v_lshlrev_b32 v40, 16, v72
  v_and_b32 v41, 0xffff0000, v72
  v_lshlrev_b32 v42, 16, v73
  v_and_b32 v43, 0xffff0000, v73
  v_lshlrev_b32 v44, 16, v74
  v_and_b32 v45, 0xffff0000, v74
  v_lshlrev_b32 v46, 16, v75
  v_and_b32 v47, 0xffff0000, v75
  v_lshlrev_b32 v48, 16, v76
  v_and_b32 v49, 0xffff0000, v76
  v_lshlrev_b32 v50, 16, v77
  v_and_b32 v51, 0xffff0000, v77
  v_lshlrev_b32 v52, 16, v78
  v_and_b32 v53, 0xffff0000, v78
  v_lshlrev_b32 v54, 16, v79
  v_and_b32 v55, 0xffff0000, v79
  v_lshlrev_b32 v56, 16, v80
  v_and_b32 v57, 0xffff0000, v80
  v_pk_mul_f32 v[40:41], v[40:41], v[66:67] op_sel_hi:[1,0]
  v_pk_mul_f32 v[42:43], v[42:43], v[66:67] op_sel_hi:[1,0]
  v_pk_mul_f32 v[44:45], v[44:45], v[66:67] op_sel_hi:[1,0]
  v_pk_mul_f32 v[46:47], v[46:47], v[66:67] op_sel_hi:[1,0]
  v_pk_mul_f32 v[48:49], v[48:49], v[66:67] op_sel_hi:[1,0]
  v_pk_mul_f32 v[50:51], v[50:51], v[66:67] op_sel_hi:[1,0]
  v_pk_mul_f32 v[52:53], v[52:53], v[66:67] op_sel_hi:[1,0]
  v_pk_mul_f32 v[54:55], v[54:55], v[66:67] op_sel_hi:[1,0]
  v_pk_mul_f32 v[56:57], v[56:57], v[66:67] op_sel_hi:[1,0]
  v_cvt_pk_bf16_f32 v72, v40, v41
  v_cvt_pk_bf16_f32 v73, v42, v43
  v_cvt_pk_bf16_f32 v74, v44, v45
  v_cvt_pk_bf16_f32 v75, v46, v47
  v_cvt_pk_bf16_f32 v76, v48, v49
  v_cvt_pk_bf16_f32 v77, v50, v51
  v_cvt_pk_bf16_f32 v78, v52, v53
  v_cvt_pk_bf16_f32 v79, v54, v55
  v_cvt_pk_bf16_f32 v80, v56, v57
  s_waitcnt lgkmcnt(0)
  s_mov_b32 s34, 8192
  s_mov_b32 s35, 16384
  buffer_store_dwordx4 v[96:99], v92, s[16:19], 0 offen
  buffer_store_dwordx4 v[100:103], v92, s[16:19], s34 offen
  ds_write_b32 v5, v72 offset:18688
  ds_write_b32 v5, v73 offset:18816
  ds_write_b32 v5, v74 offset:18944
  ds_write_b32 v5, v75 offset:19072
  ds_write_b32 v5, v76 offset:19200
  ds_write_b32 v5, v77 offset:19328
  ds_write_b32 v5, v78 offset:19456
  ds_write_b32 v5, v79 offset:19584
  ds_write_b32 v5, v80 offset:19712
  v_readfirstlane_b32 s36, v0
  s_waitcnt lgkmcnt(0)
  s_barrier
  ds_read_b128 v[20:23], v84 offset:18688
  ds_read_b128 v[24:27], v85 offset:18688
  s_cmp_ge_u32 s36, 128
  s_cbranch_scc1 L0_ln2
  ds_read_b128 v[28:31], v86 offset:18688
  buffer_store_dwordx4 v[104:107], v92, s[16:19], s35 offen
  s_waitcnt lgkmcnt(0)
  buffer_store_dwordx4 v[28:31], v89, s[20:23], s30 offen
L0_ln2:
  s_waitcnt lgkmcnt(0)
  buffer_store_dwordx4 v[20:23], v87, s[20:23], s30 offen
  buffer_store_dwordx4 v[24:27], v88, s[20:23], s30 offen
  s_endpgm
L0_wprep:
  s_cmp_ge_u32 s2, 236
  s_cbranch_scc1 L0_wo
  s_sub_u32 s3, s2, 128
  s_mul_i32 s20, s3, 43
  s_lshr_b32 s20, s20, 7
  s_mul_i32 s21, s20, 3
  s_sub_u32 s21, s3, s21
  s_mul_i32 s22, s20, 57
  s_lshr_b32 s22, s22, 9
  s_mul_i32 s23, s22, 9
  s_sub_u32 s23, s20, s23
  s_mul_i32 s24, s23, 43
  s_lshr_b32 s24, s24, 7
  s_mul_i32 s25, s24, 3
  s_sub_u32 s25, s23, s25
  s_mul_i32 s26, s21, 663552
  s_mul_i32 s27, s24, 1152
  s_add_u32 s26, s26, s27
  s_mul_i32 s27, s22, 288
  s_add_u32 s26, s26, s27
  s_mul_i32 s25, s25, 6
  s_mul_i32 s27, s3, 18432
  s_waitcnt lgkmcnt(0)
  s_mov_b32 s12, s6
  s_mov_b32 s13, s7
  s_mov_b32 s14, 1990656
  s_mov_b32 s15, 0x20000
  s_add_u32 s16, s8, 6291456
  s_addc_u32 s17, s9, 0
  s_mov_b32 s18, 1990656
  s_mov_b32 s19, 0x20000
  s_add_u32 s18, s27, 18432
  v_add_u32 v1, 0, v0
  v_mul_u32_u24 v2, 5462, v1
  v_lshrrev_b32 v2, 20, v2
  v_mul_u32_u24 v3, 192, v2
  v_sub_u32 v4, v1, v3
  v_mul_u32_u24 v3, 10923, v4
  v_lshrrev_b32 v3, 16, v3
  v_mul_u32_u24 v5, 6, v3
  v_sub_u32 v4, v4, v5
  v_bfe_u32 v5, v3, 4, 1
  v_bfe_u32 v6, v3, 2, 1
  v_lshl_add_u32 v5, v5, 1, v6
  v_bfe_u32 v6, v3, 3, 1
  v_and_b32 v7, 3, v3
  v_lshl_add_u32 v6, v6, 2, v7
  v_lshlrev_b32 v2, 5, v2
  v_add_u32 v7, v2, v3
  v_lshlrev_b32 v7, 5, v7
  v_lshl_add_u32 v7, v4, 4, v7
  v_subrev_u32 v44, 64, v7
  v_lshl_add_u32 v2, v5, 3, v2
  v_add_u32 v2, v2, v6
  v_mul_u32_u24 v2, 3456, v2
  v_add_u32 v5, s25, v4
  v_lshrrev_b32 v6, 1, v5
  v_mul_u32_u24 v6, 36, v6
  v_and_b32 v7, 1, v5
  v_lshl_add_u32 v6, v7, 4, v6
  v_subrev_u32 v7, 16, v5
  v_mul_u32_u24 v7, 144, v7
  v_add_u32 v7, 32, v7
  v_cmp_gt_u32 vcc, 16, v5
  v_cmp_le_u32 s[40:41], 16, v5
  s_nop 0
  v_cndmask_b32 v6, v7, v6, vcc
  v_add_u32 v10, v2, v6
  s_andn2_b64 exec, -1, s[40:41]
  buffer_load_dwordx4 v[16:19], v10, s[12:15], s26 offen
  s_mov_b64 exec, -1
  v_add_u32 v1, 512, v0
  v_mul_u32_u24 v2, 5462, v1
  v_lshrrev_b32 v2, 20, v2
  v_mul_u32_u24 v3, 192, v2
  v_sub_u32 v4, v1, v3
  v_mul_u32_u24 v3, 10923, v4
  v_lshrrev_b32 v3, 16, v3
  v_mul_u32_u24 v5, 6, v3
  v_sub_u32 v4, v4, v5
  v_bfe_u32 v5, v3, 4, 1
  v_bfe_u32 v6, v3, 2, 1
  v_lshl_add_u32 v5, v5, 1, v6
  v_bfe_u32 v6, v3, 3, 1
  v_and_b32 v7, 3, v3
  v_lshl_add_u32 v6, v6, 2, v7
  v_lshlrev_b32 v2, 5, v2
  v_add_u32 v7, v2, v3
  v_lshlrev_b32 v7, 5, v7
  v_lshl_add_u32 v7, v4, 4, v7
  v_subrev_u32 v45, 64, v7
  v_lshl_add_u32 v2, v5, 3, v2
  v_add_u32 v2, v2, v6
  v_mul_u32_u24 v2, 3456, v2
  v_add_u32 v5, s25, v4
  v_lshrrev_b32 v6, 1, v5
  v_mul_u32_u24 v6, 36, v6
  v_and_b32 v7, 1, v5
  v_lshl_add_u32 v6, v7, 4, v6
  v_subrev_u32 v7, 16, v5
  v_mul_u32_u24 v7, 144, v7
  v_add_u32 v7, 32, v7
  v_cmp_gt_u32 vcc, 16, v5
  v_cmp_le_u32 s[42:43], 16, v5
  s_nop 0
  v_cndmask_b32 v6, v7, v6, vcc
  v_add_u32 v11, v2, v6
  s_andn2_b64 exec, -1, s[42:43]
  buffer_load_dwordx4 v[24:27], v11, s[12:15], s26 offen
  s_mov_b64 exec, -1
  v_add_u32 v1, 1024, v0
  v_mul_u32_u24 v2, 5462, v1
  v_lshrrev_b32 v2, 20, v2
  v_mul_u32_u24 v3, 192, v2
  v_sub_u32 v4, v1, v3
  v_mul_u32_u24 v3, 10923, v4
  v_lshrrev_b32 v3, 16, v3
  v_mul_u32_u24 v5, 6, v3
  v_sub_u32 v4, v4, v5
  v_bfe_u32 v5, v3, 4, 1
  v_bfe_u32 v6, v3, 2, 1
  v_lshl_add_u32 v5, v5, 1, v6
  v_bfe_u32 v6, v3, 3, 1
  v_and_b32 v7, 3, v3
  v_lshl_add_u32 v6, v6, 2, v7
  v_lshlrev_b32 v2, 5, v2
  v_add_u32 v7, v2, v3
  v_lshlrev_b32 v7, 5, v7
  v_lshl_add_u32 v7, v4, 4, v7
  v_subrev_u32 v46, 64, v7
  v_lshl_add_u32 v2, v5, 3, v2
  v_add_u32 v2, v2, v6
  v_mul_u32_u24 v2, 3456, v2
  v_add_u32 v5, s25, v4
  v_lshrrev_b32 v6, 1, v5
  v_mul_u32_u24 v6, 36, v6
  v_and_b32 v7, 1, v5
  v_lshl_add_u32 v6, v7, 4, v6
  v_subrev_u32 v7, 16, v5
  v_mul_u32_u24 v7, 144, v7
  v_add_u32 v7, 32, v7
  v_cmp_gt_u32 vcc, 16, v5
  v_cmp_le_u32 s[44:45], 16, v5
  s_nop 0
  v_cndmask_b32 v6, v7, v6, vcc
  v_add_u32 v12, v2, v6
  s_andn2_b64 exec, -1, s[44:45]
  buffer_load_dwordx4 v[32:35], v12, s[12:15], s26 offen
  s_mov_b64 exec, -1
  v_lshlrev_b32 v1, 4, v0
  s_cmp_lt_u32 s25, 12
  s_cbranch_scc1 L0_wpst
  v_add_u32 v2, 0, v0
  v_and_b32 v3, 7, v2
  v_lshrrev_b32 v2, 3, v2
  v_and_b32 v4, 0xe3, v2
  v_bfe_u32 v5, v2, 4, 1
  v_lshl_add_u32 v4, v5, 4, v4
  v_bfe_u32 v5, v2, 2, 1
  v_lshl_add_u32 v4, v5, 3, v4
  v_bfe_u32 v5, v2, 3, 1
  v_lshl_add_u32 v4, v5, 2, v4
  v_mul_u32_u24 v4, 3456, v4
  v_mul_u32_u24 v3, 36, v3
  v_add3_u32 v4, v4, v3, 32
  buffer_load_dword v40, v4, s[12:15], s26 offen
  v_add_u32 v2, 512, v0
  v_and_b32 v3, 7, v2
  v_lshrrev_b32 v2, 3, v2
  v_and_b32 v4, 0xe3, v2
  v_bfe_u32 v5, v2, 4, 1
  v_lshl_add_u32 v4, v5, 4, v4
  v_bfe_u32 v5, v2, 2, 1
  v_lshl_add_u32 v4, v5, 3, v4
  v_bfe_u32 v5, v2, 3, 1
  v_lshl_add_u32 v4, v5, 2, v4
  v_mul_u32_u24 v4, 3456, v4
  v_mul_u32_u24 v3, 36, v3
  v_add3_u32 v4, v4, v3, 32
  buffer_load_dword v41, v4, s[12:15], s26 offen
  v_add_u32 v2, 1024, v0
  v_and_b32 v3, 7, v2
  v_lshrrev_b32 v2, 3, v2
  v_and_b32 v4, 0xe3, v2
  v_bfe_u32 v5, v2, 4, 1
  v_lshl_add_u32 v4, v5, 4, v4
  v_bfe_u32 v5, v2, 2, 1
  v_lshl_add_u32 v4, v5, 3, v4
  v_bfe_u32 v5, v2, 3, 1
  v_lshl_add_u32 v4, v5, 2, v4
  v_mul_u32_u24 v4, 3456, v4
  v_mul_u32_u24 v3, 36, v3
  v_add3_u32 v4, v4, v3, 32
  buffer_load_dword v42, v4, s[12:15], s26 offen
  v_lshlrev_b32 v2, 2, v0
  s_waitcnt vmcnt(2)
  ds_write_b32 v2, v40 offset:0
  s_waitcnt vmcnt(1)
  ds_write_b32 v2, v41 offset:2048
  s_waitcnt vmcnt(0)
  ds_write_b32 v2, v42 offset:4096
  s_waitcnt lgkmcnt(0)
  s_barrier
  s_mov_b64 exec, s[40:41]
  ds_read_b128 v[16:19], v44
  s_mov_b64 exec, s[42:43]
  ds_read_b128 v[24:27], v45
  s_mov_b64 exec, s[44:45]
  ds_read_b128 v[32:35], v46
  s_mov_b64 exec, -1
  s_waitcnt lgkmcnt(0)
L0_wpst:
  s_mov_b32 s48, s28
  s_mov_b32 s49, s29
  s_mov_b32 s50, 18874368
  s_mov_b32 s51, 0x20000
  s_waitcnt vmcnt(2)
  s_add_u32 s28, s27, 0
  buffer_store_dwordx4 v[16:19], v1, s[16:19], s28 offen
  s_waitcnt vmcnt(2)
  s_add_u32 s28, s27, 8192
  buffer_store_dwordx4 v[24:27], v1, s[16:19], s28 offen
  s_waitcnt vmcnt(2)
  s_add_u32 s28, s27, 16384
  buffer_store_dwordx4 v[32:35], v1, s[16:19], s28 offen
  s_endpgm
L0_wo:
  s_sub_u32 s3, s2, 236
  s_mul_i32 s27, s3, 3072
  s_mul_i32 s26, s3, 41472
  s_sub_u32 s20, s3, 16
  s_mul_i32 s20, s20, 331776
  s_cmp_lt_u32 s3, 16
  s_cselect_b32 s26, s26, s20
  s_cselect_b64 s[40:41], -1, 0
  s_waitcnt lgkmcnt(0)
  s_mov_b32 s12, s10
  s_mov_b32 s13, s11
  s_mov_b32 s14, 663552
  s_mov_b32 s15, 0x20000
  s_add_u32 s16, s8, 8388608
  s_addc_u32 s17, s9, 0
  s_mov_b32 s18, 663552
  s_mov_b32 s19, 0x20000
  v_add_u32 v1, 0, v0
  v_mul_u32_u24 v2, 5462, v1
  v_lshrrev_b32 v2, 20, v2
  v_mul_u32_u24 v3, 192, v2
  v_sub_u32 v4, v1, v3
  v_mul_u32_u24 v3, 10923, v4
  v_lshrrev_b32 v3, 16, v3
  v_mul_u32_u24 v5, 6, v3
  v_sub_u32 v4, v4, v5
  v_bfe_u32 v5, v3, 4, 1
  v_bfe_u32 v6, v3, 2, 1
  v_lshl_add_u32 v5, v5, 1, v6
  v_bfe_u32 v6, v3, 3, 1
  v_and_b32 v7, 3, v3
  v_lshl_add_u32 v6, v6, 2, v7
  v_lshrrev_b32 v7, 1, v5
  v_mul_u32_u24 v7, 18, v7
  v_and_b32 v8, 1, v5
  v_lshl_add_u32 v7, v8, 2, v7
  v_and_b32 v8, 3, v6
  v_add_u32 v7, v7, v8
  v_lshrrev_b32 v8, 2, v6
  v_lshl_add_u32 v7, v8, 3, v7
  v_lshrrev_b32 v9, 1, v6
  v_lshl_add_u32 v8, v5, 2, v9
  v_mul_u32_u24 v8, 18, v8
  v_and_b32 v9, 1, v6
  v_add3_u32 v8, v8, v9, 16
  v_cndmask_b32 v7, v8, v7, s[40:41]
  v_mul_u32_u24 v7, 1152, v7
  v_lshl_add_u32 v7, v4, 4, v7
  v_mul_u32_u24 v8, 96, v2
  v_add_u32 v7, v7, v8
  buffer_load_dwordx4 v[16:19], v7, s[12:15], s26 offen
  v_mul_u32_u24 v8, 52224, v2
  v_lshl_add_u32 v40, v1, 4, v8
  v_add_u32 v1, 512, v0
  v_mul_u32_u24 v2, 5462, v1
  v_lshrrev_b32 v2, 20, v2
  v_mul_u32_u24 v3, 192, v2
  v_sub_u32 v4, v1, v3
  v_mul_u32_u24 v3, 10923, v4
  v_lshrrev_b32 v3, 16, v3
  v_mul_u32_u24 v5, 6, v3
  v_sub_u32 v4, v4, v5
  v_bfe_u32 v5, v3, 4, 1
  v_bfe_u32 v6, v3, 2, 1
  v_lshl_add_u32 v5, v5, 1, v6
  v_bfe_u32 v6, v3, 3, 1
  v_and_b32 v7, 3, v3
  v_lshl_add_u32 v6, v6, 2, v7
  v_lshrrev_b32 v7, 1, v5
  v_mul_u32_u24 v7, 18, v7
  v_and_b32 v8, 1, v5
  v_lshl_add_u32 v7, v8, 2, v7
  v_and_b32 v8, 3, v6
  v_add_u32 v7, v7, v8
  v_lshrrev_b32 v8, 2, v6
  v_lshl_add_u32 v7, v8, 3, v7
  v_lshrrev_b32 v9, 1, v6
  v_lshl_add_u32 v8, v5, 2, v9
  v_mul_u32_u24 v8, 18, v8
  v_and_b32 v9, 1, v6
  v_add3_u32 v8, v8, v9, 16
  v_cndmask_b32 v7, v8, v7, s[40:41]
  v_mul_u32_u24 v7, 1152, v7
  v_lshl_add_u32 v7, v4, 4, v7
  v_mul_u32_u24 v8, 96, v2
  v_add_u32 v7, v7, v8
  buffer_load_dwordx4 v[20:23], v7, s[12:15], s26 offen
  v_mul_u32_u24 v8, 52224, v2
  v_lshl_add_u32 v41, v1, 4, v8
  v_add_u32 v1, 1024, v0
  v_mul_u32_u24 v2, 5462, v1
  v_lshrrev_b32 v2, 20, v2
  v_mul_u32_u24 v3, 192, v2
  v_sub_u32 v4, v1, v3
  v_mul_u32_u24 v3, 10923, v4
  v_lshrrev_b32 v3, 16, v3
  v_mul_u32_u24 v5, 6, v3
  v_sub_u32 v4, v4, v5
  v_bfe_u32 v5, v3, 4, 1
  v_bfe_u32 v6, v3, 2, 1
  v_lshl_add_u32 v5, v5, 1, v6
  v_bfe_u32 v6, v3, 3, 1
  v_and_b32 v7, 3, v3
  v_lshl_add_u32 v6, v6, 2, v7
  v_lshrrev_b32 v7, 1, v5
  v_mul_u32_u24 v7, 18, v7
  v_and_b32 v8, 1, v5
  v_lshl_add_u32 v7, v8, 2, v7
  v_and_b32 v8, 3, v6
  v_add_u32 v7, v7, v8
  v_lshrrev_b32 v8, 2, v6
  v_lshl_add_u32 v7, v8, 3, v7
  v_lshrrev_b32 v9, 1, v6
  v_lshl_add_u32 v8, v5, 2, v9
  v_mul_u32_u24 v8, 18, v8
  v_and_b32 v9, 1, v6
  v_add3_u32 v8, v8, v9, 16
  v_cndmask_b32 v7, v8, v7, s[40:41]
  v_mul_u32_u24 v7, 1152, v7
  v_lshl_add_u32 v7, v4, 4, v7
  v_mul_u32_u24 v8, 96, v2
  v_add_u32 v7, v7, v8
  buffer_load_dwordx4 v[24:27], v7, s[12:15], s26 offen
  v_mul_u32_u24 v8, 52224, v2
  v_lshl_add_u32 v42, v1, 4, v8
  v_add_u32 v1, 1536, v0
  v_mul_u32_u24 v2, 5462, v1
  v_lshrrev_b32 v2, 20, v2
  v_mul_u32_u24 v3, 192, v2
  v_sub_u32 v4, v1, v3
  v_mul_u32_u24 v3, 10923, v4
  v_lshrrev_b32 v3, 16, v3
  v_mul_u32_u24 v5, 6, v3
  v_sub_u32 v4, v4, v5
  v_bfe_u32 v5, v3, 4, 1
  v_bfe_u32 v6, v3, 2, 1
  v_lshl_add_u32 v5, v5, 1, v6
  v_bfe_u32 v6, v3, 3, 1
  v_and_b32 v7, 3, v3
  v_lshl_add_u32 v6, v6, 2, v7
  v_lshrrev_b32 v7, 1, v5
  v_mul_u32_u24 v7, 18, v7
  v_and_b32 v8, 1, v5
  v_lshl_add_u32 v7, v8, 2, v7
  v_and_b32 v8, 3, v6
  v_add_u32 v7, v7, v8
  v_lshrrev_b32 v8, 2, v6
  v_lshl_add_u32 v7, v8, 3, v7
  v_lshrrev_b32 v9, 1, v6
  v_lshl_add_u32 v8, v5, 2, v9
  v_mul_u32_u24 v8, 18, v8
  v_and_b32 v9, 1, v6
  v_add3_u32 v8, v8, v9, 16
  v_cndmask_b32 v7, v8, v7, s[40:41]
  v_mul_u32_u24 v7, 1152, v7
  v_lshl_add_u32 v7, v4, 4, v7
  v_mul_u32_u24 v8, 96, v2
  v_add_u32 v7, v7, v8
  buffer_load_dwordx4 v[28:31], v7, s[12:15], s26 offen
  v_mul_u32_u24 v8, 52224, v2
  v_lshl_add_u32 v43, v1, 4, v8
  v_add_u32 v1, 2048, v0
  v_mul_u32_u24 v2, 5462, v1
  v_lshrrev_b32 v2, 20, v2
  v_mul_u32_u24 v3, 192, v2
  v_sub_u32 v4, v1, v3
  v_mul_u32_u24 v3, 10923, v4
  v_lshrrev_b32 v3, 16, v3
  v_mul_u32_u24 v5, 6, v3
  v_sub_u32 v4, v4, v5
  v_bfe_u32 v5, v3, 4, 1
  v_bfe_u32 v6, v3, 2, 1
  v_lshl_add_u32 v5, v5, 1, v6
  v_bfe_u32 v6, v3, 3, 1
  v_and_b32 v7, 3, v3
  v_lshl_add_u32 v6, v6, 2, v7
  v_lshrrev_b32 v7, 1, v5
  v_mul_u32_u24 v7, 18, v7
  v_and_b32 v8, 1, v5
  v_lshl_add_u32 v7, v8, 2, v7
  v_and_b32 v8, 3, v6
  v_add_u32 v7, v7, v8
  v_lshrrev_b32 v8, 2, v6
  v_lshl_add_u32 v7, v8, 3, v7
  v_lshrrev_b32 v9, 1, v6
  v_lshl_add_u32 v8, v5, 2, v9
  v_mul_u32_u24 v8, 18, v8
  v_and_b32 v9, 1, v6
  v_add3_u32 v8, v8, v9, 16
  v_cndmask_b32 v7, v8, v7, s[40:41]
  v_mul_u32_u24 v7, 1152, v7
  v_lshl_add_u32 v7, v4, 4, v7
  v_mul_u32_u24 v8, 96, v2
  v_add_u32 v7, v7, v8
  buffer_load_dwordx4 v[32:35], v7, s[12:15], s26 offen
  v_mul_u32_u24 v8, 52224, v2
  v_lshl_add_u32 v44, v1, 4, v8
  s_mov_b32 s48, s28
  s_mov_b32 s49, s29
  s_mov_b32 s50, 18874368
  s_mov_b32 s51, 0x20000
  s_waitcnt vmcnt(4)
  buffer_store_dwordx4 v[16:19], v40, s[16:19], s27 offen
  s_waitcnt vmcnt(4)
  buffer_store_dwordx4 v[20:23], v41, s[16:19], s27 offen
  s_waitcnt vmcnt(4)
  buffer_store_dwordx4 v[24:27], v42, s[16:19], s27 offen
  s_waitcnt vmcnt(4)
  buffer_store_dwordx4 v[28:31], v43, s[16:19], s27 offen
  s_waitcnt vmcnt(4)
  buffer_store_dwordx4 v[32:35], v44, s[16:19], s27 offen
  s_endpgm
L0_end:
  s_endpgm
  .globl k1_kernel
  .p2align 8
  .type k1_kernel,@function
k1_kernel:
  s_cmp_ge_u32 s2, 256
  s_cbranch_scc1 L1_end
  s_load_dwordx4 s[4:7], s[0:1], 32
  s_load_dwordx2 s[8:9], s[0:1], 80
  s_and_b32 s36, s2, 7
  s_cmp_ge_u32 s36, 6
  s_cbranch_scc1 L1_qkv
  s_and_b32 s36, s2, 7
  s_lshr_b32 s37, s2, 3
  s_and_b32 s38, s37, 3
  s_lshr_b32 s37, s37, 2
  s_mul_i32 s36, s36, 8
  s_add_u32 s36, s36, s37
  s_mul_i32 s40, s36, 192
  v_lshrrev_b32 v2, 6, v0
  v_and_b32 v1, 63, v0
  v_readfirstlane_b32 s18, v2
  v_lshrrev_b32 v2, 4, v1
  v_and_b32 v3, 15, v1
  v_lshrrev_b32 v4, 2, v3
  v_and_b32 v5, 3, v3
  s_waitcnt lgkmcnt(0)
  s_cmp_lt_u32 s18, 4
  s_cbranch_scc1 L1_mc
  s_add_u32 s20, s8, 3145728
  s_addc_u32 s21, s9, 0
  s_mov_b32 s22, 2359296
  s_mov_b32 s23, 0x20000
  s_mov_b32 s24, s4
  s_mov_b32 s25, s5
  s_mov_b32 s26, 18874368
  s_mov_b32 s27, 0x20000
  s_sub_u32 s19, s18, 4
  s_mul_i32 s60, s38, 589824
  s_add_u32 s22, s60, 589824
  s_mov_b32 s59, 0
  s_mul_i32 s61, s37, 43
  s_lshr_b32 s61, s61, 4
  s_lshl_b32 s62, s38, 2
  s_add_u32 s61, s61, s62
  s_add_u32 s61, s37, s38
  s_and_b32 s61, s61, 3
  s_mov_b32 s66, 0
  s_and_b32 s67, s2, 7
  s_lshl_b32 s67, s67, 2
  s_mul_i32 s45, s19, 5
  s_lshl_b32 s46, s19, 2
  s_add_u32 s46, s46, 2
  s_cmp_lt_u32 s19, 2
  s_cselect_b32 s45, s45, s46
  s_lshl_b32 s47, s45, 10
  v_lshl_add_u32 v10, v1, 4, s47
  v_add_u32 v11, 4096, v10
  s_mul_i32 s50, s19, 192
  s_mul_i32 s51, s19, 3072
  s_add_u32 s51, s51, 18432
  v_add_u32 v6, s50, v1
  v_add_u32 v6, 0, v6
  v_mul_u32_u24 v7, 5462, v6
  v_lshrrev_b32 v7, 16, v7
  v_mul_u32_u24 v8, 12, v7
  v_sub_u32 v8, v6, v8
  v_bfe_u32 v9, v7, 2, 1
  v_lshlrev_b32 v9, 1, v9
  v_xor_b32 v8, v8, v9
  v_mul_u32_u24 v7, 9216, v7
  v_lshl_add_u32 v7, v8, 4, v7
  v_add_u32 v7, s40, v7
  v_subrev_u32 v15, 0, v7
  v_add_u32 v6, s50, v1
  v_add_u32 v6, 64, v6
  v_mul_u32_u24 v7, 5462, v6
  v_lshrrev_b32 v7, 16, v7
  v_mul_u32_u24 v8, 12, v7
  v_sub_u32 v8, v6, v8
  v_bfe_u32 v9, v7, 2, 1
  v_lshlrev_b32 v9, 1, v9
  v_xor_b32 v8, v8, v9
  v_mul_u32_u24 v7, 9216, v7
  v_lshl_add_u32 v7, v8, 4, v7
  v_add_u32 v7, s40, v7
  v_subrev_u32 v16, 1024, v7
  v_add_u32 v6, s50, v1
  v_add_u32 v6, 128, v6
  v_mul_u32_u24 v7, 5462, v6
  v_lshrrev_b32 v7, 16, v7
  v_mul_u32_u24 v8, 12, v7
  v_sub_u32 v8, v6, v8
  v_bfe_u32 v9, v7, 2, 1
  v_lshlrev_b32 v9, 1, v9
  v_xor_b32 v8, v8, v9
  v_mul_u32_u24 v7, 9216, v7
  v_lshl_add_u32 v7, v8, 4, v7
  v_add_u32 v7, s40, v7
  v_subrev_u32 v17, 2048, v7
  s_cmp_lt_u32 s19, 2
  s_cbranch_scc1 L1_ml5
  s_mov_b32 s53, 0
  s_lshr_b32 s63, s66, 0
  s_and_b32 s62, s63, 3
  s_cmp_eq_u32 s62, s61
  s_cselect_b32 s62, 4, 0
  s_cselect_b32 s63, 1, 0
  s_cmp_ge_u32 s66, 28
  s_cselect_b32 s62, s63, s62
  s_cselect_b32 s63, s63, 0
  s_add_u32 s58, s66, s62
  s_add_u32 s63, s63, 1
  s_mul_i32 s62, s61, 1
  s_add_u32 s62, s62, s59
  s_cmp_lt_u32 s59, 1
  s_cselect_b32 s58, s62, s58
  s_cselect_b32 s63, 0, s63
  s_add_u32 s66, s66, s63
  s_add_u32 s59, s59, 1
  s_mul_i32 s52, s58, 18432
  s_add_u32 s52, s52, s60
  s_mul_i32 s54, s58, 589824
  s_add_u32 s64, s53, s47
  s_add_u32 m0, s53, s51
  s_mov_b32 s57, 0
Lldm4_1:
  buffer_load_dwordx4 v15, s[24:27], s54 offen offset:0 lds
  buffer_load_dwordx4 v16, s[24:27], s54 offen offset:1024 lds
  buffer_load_dwordx4 v17, s[24:27], s54 offen offset:2048 lds
  s_mov_b32 m0, s64
  s_nop 0
  buffer_load_dwordx4 v10, s[20:23], s52 offen offset:0 lds
  buffer_load_dwordx4 v10, s[20:23], s52 offen offset:1024 lds
  buffer_load_dwordx4 v10, s[20:23], s52 offen offset:2048 lds
  buffer_load_dwordx4 v10, s[20:23], s52 offen offset:3072 lds
  s_add_u32 s53, s53, 30720
  s_cmp_eq_u32 s53, 122880
  s_cselect_b32 s53, 0, s53
  s_lshr_b32 s63, s66, 0
  s_and_b32 s62, s63, 3
  s_cmp_eq_u32 s62, s61
  s_cselect_b32 s62, 4, 0
  s_cselect_b32 s63, 1, 0
  s_cmp_ge_u32 s66, 28
  s_cselect_b32 s62, s63, s62
  s_cselect_b32 s63, s63, 0
  s_add_u32 s58, s66, s62
  s_add_u32 s63, s63, 1
  s_mul_i32 s62, s61, 1
  s_add_u32 s62, s62, s59
  s_cmp_lt_u32 s59, 1
  s_cselect_b32 s58, s62, s58
  s_cselect_b32 s63, 0, s63
  s_add_u32 s66, s66, s63
  s_add_u32 s59, s59, 1
  s_mul_i32 s52, s58, 18432
  s_add_u32 s52, s52, s60
  s_mul_i32 s54, s58, 589824
  s_add_u32 s64, s53, s47
  s_add_u32 m0, s53, s51
  s_add_u32 s57, s57, 1
  s_cmp_lg_u32 s57, 2
  s_cbranch_scc1 Lldm4_3
  s_waitcnt vmcnt(7)
  s_barrier
Lldm4_3:
  s_cmp_lt_u32 s57, 4
  s_cbranch_scc1 Lldm4_1
Lldm4_2:
  s_waitcnt vmcnt(14)
  s_barrier
  buffer_load_dwordx4 v15, s[24:27], s54 offen offset:0 lds
  buffer_load_dwordx4 v16, s[24:27], s54 offen offset:1024 lds
  buffer_load_dwordx4 v17, s[24:27], s54 offen offset:2048 lds
  s_mov_b32 m0, s64
  s_nop 0
  buffer_load_dwordx4 v10, s[20:23], s52 offen offset:0 lds
  buffer_load_dwordx4 v10, s[20:23], s52 offen offset:1024 lds
  buffer_load_dwordx4 v10, s[20:23], s52 offen offset:2048 lds
  buffer_load_dwordx4 v10, s[20:23], s52 offen offset:3072 lds
  s_add_u32 s53, s53, 30720
  s_cmp_eq_u32 s53, 122880
  s_cselect_b32 s53, 0, s53
  s_lshr_b32 s63, s66, 0
  s_and_b32 s62, s63, 3
  s_cmp_eq_u32 s62, s61
  s_cselect_b32 s62, 4, 0
  s_cselect_b32 s63, 1, 0
  s_cmp_ge_u32 s66, 28
  s_cselect_b32 s62, s63, s62
  s_cselect_b32 s63, s63, 0
  s_add_u32 s58, s66, s62
  s_add_u32 s63, s63, 1
  s_mul_i32 s62, s61, 1
  s_add_u32 s62, s62, s59
  s_cmp_lt_u32 s59, 1
  s_cselect_b32 s58, s62, s58
  s_cselect_b32 s63, 0, s63
  s_add_u32 s66, s66, s63
  s_add_u32 s59, s59, 1
  s_mul_i32 s52, s58, 18432
  s_add_u32 s52, s52, s60
  s_mul_i32 s54, s58, 589824
  s_add_u32 s64, s53, s47
  s_add_u32 m0, s53, s51
  s_add_u32 s57, s57, 1
  s_cmp_lt_u32 s57, 32
  s_cbranch_scc1 Lldm4_2
  s_waitcnt vmcnt(14)
  s_barrier
  s_waitcnt vmcnt(7)
  s_barrier
  s_waitcnt vmcnt(0)
  s_barrier
  s_waitcnt vmcnt(0)
  s_barrier
  s_endpgm
L1_ml5:
  s_mov_b32 s53, 0
  s_lshr_b32 s63, s66, 0
  s_and_b32 s62, s63, 3
  s_cmp_eq_u32 s62, s61
  s_cselect_b32 s62, 4, 0
  s_cselect_b32 s63, 1, 0
  s_cmp_ge_u32 s66, 28
  s_cselect_b32 s62, s63, s62
  s_cselect_b32 s63, s63, 0
  s_add_u32 s58, s66, s62
  s_add_u32 s63, s63, 1
  s_mul_i32 s62, s61, 1
  s_add_u32 s62, s62, s59
  s_cmp_lt_u32 s59, 1
  s_cselect_b32 s58, s62, s58
  s_cselect_b32 s63, 0, s63
  s_add_u32 s66, s66, s63
  s_add_u32 s59, s59, 1
  s_mul_i32 s52, s58, 18432
  s_add_u32 s52, s52, s60
  s_mul_i32 s54, s58, 589824
  s_add_u32 s64, s53, s47
  s_add_u32 m0, s53, s51
  s_mov_b32 s57, 0
Lldm5_4:
  buffer_load_dwordx4 v15, s[24:27], s54 offen offset:0 lds
  buffer_load_dwordx4 v16, s[24:27], s54 offen offset:1024 lds
  buffer_load_dwordx4 v17, s[24:27], s54 offen offset:2048 lds
  s_mov_b32 m0, s64
  s_nop 0
  buffer_load_dwordx4 v10, s[20:23], s52 offen offset:0 lds
  buffer_load_dwordx4 v10, s[20:23], s52 offen offset:1024 lds
  buffer_load_dwordx4 v10, s[20:23], s52 offen offset:2048 lds
  buffer_load_dwordx4 v10, s[20:23], s52 offen offset:3072 lds
  s_add_u32 m0, m0, 4096
  s_nop 0
  buffer_load_dwordx4 v11, s[20:23], s52 offen lds
  s_add_u32 s53, s53, 30720
  s_cmp_eq_u32 s53, 122880
  s_cselect_b32 s53, 0, s53
  s_lshr_b32 s63, s66, 0
  s_and_b32 s62, s63, 3
  s_cmp_eq_u32 s62, s61
  s_cselect_b32 s62, 4, 0
  s_cselect_b32 s63, 1, 0
  s_cmp_ge_u32 s66, 28
  s_cselect_b32 s62, s63, s62
  s_cselect_b32 s63, s63, 0
  s_add_u32 s58, s66, s62
  s_add_u32 s63, s63, 1
  s_mul_i32 s62, s61, 1
  s_add_u32 s62, s62, s59
  s_cmp_lt_u32 s59, 1
  s_cselect_b32 s58, s62, s58
  s_cselect_b32 s63, 0, s63
  s_add_u32 s66, s66, s63
  s_add_u32 s59, s59, 1
  s_mul_i32 s52, s58, 18432
  s_add_u32 s52, s52, s60
  s_mul_i32 s54, s58, 589824
  s_add_u32 s64, s53, s47
  s_add_u32 m0, s53, s51
  s_add_u32 s57, s57, 1
  s_cmp_lg_u32 s57, 2
  s_cbranch_scc1 Lldm5_6
  s_waitcnt vmcnt(8)
  s_barrier
Lldm5_6:
  s_cmp_lt_u32 s57, 4
  s_cbranch_scc1 Lldm5_4
Lldm5_5:
  s_waitcnt vmcnt(16)
  s_barrier
  buffer_load_dwordx4 v15, s[24:27], s54 offen offset:0 lds
  buffer_load_dwordx4 v16, s[24:27], s54 offen offset:1024 lds
  buffer_load_dwordx4 v17, s[24:27], s54 offen offset:2048 lds
  s_mov_b32 m0, s64
  s_nop 0
  buffer_load_dwordx4 v10, s[20:23], s52 offen offset:0 lds
  buffer_load_dwordx4 v10, s[20:23], s52 offen offset:1024 lds
  buffer_load_dwordx4 v10, s[20:23], s52 offen offset:2048 lds
  buffer_load_dwordx4 v10, s[20:23], s52 offen offset:3072 lds
  s_add_u32 m0, m0, 4096
  s_nop 0
  buffer_load_dwordx4 v11, s[20:23], s52 offen lds
  s_add_u32 s53, s53, 30720
  s_cmp_eq_u32 s53, 122880
  s_cselect_b32 s53, 0, s53
  s_lshr_b32 s63, s66, 0
  s_and_b32 s62, s63, 3
  s_cmp_eq_u32 s62, s61
  s_cselect_b32 s62, 4, 0
  s_cselect_b32 s63, 1, 0
  s_cmp_ge_u32 s66, 28
  s_cselect_b32 s62, s63, s62
  s_cselect_b32 s63, s63, 0
  s_add_u32 s58, s66, s62
  s_add_u32 s63, s63, 1
  s_mul_i32 s62, s61, 1
  s_add_u32 s62, s62, s59
  s_cmp_lt_u32 s59, 1
  s_cselect_b32 s58, s62, s58
  s_cselect_b32 s63, 0, s63
  s_add_u32 s66, s66, s63
  s_add_u32 s59, s59, 1
  s_mul_i32 s52, s58, 18432
  s_add_u32 s52, s52, s60
  s_mul_i32 s54, s58, 589824
  s_add_u32 s64, s53, s47
  s_add_u32 m0, s53, s51
  s_add_u32 s57, s57, 1
  s_cmp_lt_u32 s57, 32
  s_cbranch_scc1 Lldm5_5
  s_waitcnt vmcnt(16)
  s_barrier
  s_waitcnt vmcnt(8)
  s_barrier
  s_waitcnt vmcnt(0)
  s_barrier
  s_waitcnt vmcnt(0)
  s_barrier
  s_endpgm
L1_mc:
  s_add_u32 s28, s8, 20971520
  s_addc_u32 s29, s9, 0
  s_mov_b32 s30, 5308416
  s_mov_b32 s31, 0x20000
  s_mov_b32 s32, s6
  s_mov_b32 s33, s7
  s_mov_b32 s34, 9216
  s_mov_b32 s35, 0x20000
  s_and_b32 s41, s18, 1
  s_lshr_b32 s42, s18, 1
  s_mul_i32 s43, s41, 96
  s_add_u32 s43, s43, s40
  v_lshl_add_u32 v6, v3, 1, s43
  buffer_load_short_d16_hi v150, v6, s[32:35], 0 offen offset:0
  buffer_load_short_d16_hi v151, v6, s[32:35], 0 offen offset:32
  buffer_load_short_d16_hi v152, v6, s[32:35], 0 offen offset:64
  s_mul_i32 s44, s36, 6
  s_mul_i32 s45, s41, 3
  s_add_u32 s44, s44, s45
  s_mul_i32 s44, s44, 36
  s_mul_i32 s45, s38, 9
  s_add_u32 s44, s44, s45
  s_lshl_b32 s45, s42, 2
  s_add_u32 s44, s44, s45
  s_lshl_b32 s44, s44, 9
  s_add_u32 s45, s44, 18432
  s_add_u32 s46, s44, 36864
  v_lshrrev_b32 v7, 1, v2
  v_lshlrev_b32 v7, 3, v7
  v_xor_b32 v7, v7, v1
  v_lshlrev_b32 v148, 3, v7
  v_lshl_add_u32 v6, v2, 2, v4
  v_mul_u32_u24 v7, 288, v6
  v_lshl_add_u32 v7, v5, 3, v7
  s_lshl_b32 s55, s42, 7
  v_add_u32 v20, s55, v7
  v_mul_u32_u24 v7, 192, v6
  v_lshl_add_u32 v7, v5, 3, v7
  v_and_b32 v8, 1, v2
  s_mul_i32 s55, s41, 3
  s_add_u32 s56, s55, 0
  v_xor_b32 v9, s56, v8
  v_lshl_add_u32 v22, v9, 5, v7
  s_add_u32 s56, s55, 1
  v_xor_b32 v9, s56, v8
  v_lshl_add_u32 v23, v9, 5, v7
  s_add_u32 s56, s55, 2
  v_xor_b32 v9, s56, v8
  v_lshl_add_u32 v24, v9, 5, v7
  v_mov_b32 v156, 0xc0135761
  v_mov_b32 v157, 0xc0135761
  v_mov_b32 v158, 0xbdd2d3e8
  v_mov_b32 v159, 0xbdd2d3e8
  v_mov_b32 v146, 1.0
  v_mov_b32 v147, 1.0
  s_waitcnt vmcnt(0)
  v_and_b32 v28, 0xffff0000, v150
  v_and_b32 v29, 0xffff0000, v150
  v_and_b32 v30, 0xffff0000, v150
  v_and_b32 v31, 0xffff0000, v150
  v_and_b32 v32, 0xffff0000, v151
  v_and_b32 v33, 0xffff0000, v151
  v_and_b32 v34, 0xffff0000, v151
  v_and_b32 v35, 0xffff0000, v151
  v_and_b32 v36, 0xffff0000, v152
  v_and_b32 v37, 0xffff0000, v152
  v_and_b32 v38, 0xffff0000, v152
  v_and_b32 v39, 0xffff0000, v152
  v_and_b32 v40, 0xffff0000, v150
  v_and_b32 v41, 0xffff0000, v150
  v_and_b32 v42, 0xffff0000, v150
  v_and_b32 v43, 0xffff0000, v150
  v_and_b32 v44, 0xffff0000, v151
  v_and_b32 v45, 0xffff0000, v151
  v_and_b32 v46, 0xffff0000, v151
  v_and_b32 v47, 0xffff0000, v151
  v_and_b32 v48, 0xffff0000, v152
  v_and_b32 v49, 0xffff0000, v152
  v_and_b32 v50, 0xffff0000, v152
  v_and_b32 v51, 0xffff0000, v152
  v_and_b32 v52, 0xffff0000, v150
  v_and_b32 v53, 0xffff0000, v150
  v_and_b32 v54, 0xffff0000, v150
  v_and_b32 v55, 0xffff0000, v150
  v_and_b32 v56, 0xffff0000, v151
  v_and_b32 v57, 0xffff0000, v151
  v_and_b32 v58, 0xffff0000, v151
  v_and_b32 v59, 0xffff0000, v151
  v_and_b32 v60, 0xffff0000, v152
  v_and_b32 v61, 0xffff0000, v152
  v_and_b32 v62, 0xffff0000, v152
  v_and_b32 v63, 0xffff0000, v152
  v_and_b32 v64, 0xffff0000, v150
  v_and_b32 v65, 0xffff0000, v150
  v_and_b32 v66, 0xffff0000, v150
  v_and_b32 v67, 0xffff0000, v150
  v_and_b32 v68, 0xffff0000, v151
  v_and_b32 v69, 0xffff0000, v151
  v_and_b32 v70, 0xffff0000, v151
  v_and_b32 v71, 0xffff0000, v151
  v_and_b32 v72, 0xffff0000, v152
  v_and_b32 v73, 0xffff0000, v152
  v_and_b32 v74, 0xffff0000, v152
  v_and_b32 v75, 0xffff0000, v152
  v_and_b32 v76, 0xffff0000, v150
  v_and_b32 v77, 0xffff0000, v150
  v_and_b32 v78, 0xffff0000, v150
  v_and_b32 v79, 0xffff0000, v150
  v_and_b32 v80, 0xffff0000, v151
  v_and_b32 v81, 0xffff0000, v151
  v_and_b32 v82, 0xffff0000, v151
  v_and_b32 v83, 0xffff0000, v151
  v_and_b32 v84, 0xffff0000, v152
  v_and_b32 v85, 0xffff0000, v152
  v_and_b32 v86, 0xffff0000, v152
  v_and_b32 v87, 0xffff0000, v152
  s_barrier
  s_mov_b32 s54, 30720
  s_mov_b32 s57, 0
  s_mov_b32 s56, 0
  s_cmp_eq_u32 s42, 1
  s_cbranch_scc1 L1_m1
  ds_read_b64_tr_b16 v[160:161], v20 offset:0
  ds_read_b64_tr_b16 v[162:163], v20 offset:4608
  ds_read_b64_tr_b16 v[180:181], v22 offset:18432
  ds_read_b64_tr_b16 v[182:183], v22 offset:21504
  ds_read_b64_tr_b16 v[184:185], v23 offset:18432
  ds_read_b64_tr_b16 v[186:187], v23 offset:21504
  ds_read_b64_tr_b16 v[188:189], v24 offset:18432
  ds_read_b64_tr_b16 v[190:191], v24 offset:21504
  ds_read_b64_tr_b16 v[164:165], v20 offset:32
  ds_read_b64_tr_b16 v[166:167], v20 offset:4640
  ds_read_b64_tr_b16 v[168:169], v20 offset:64
  ds_read_b64_tr_b16 v[170:171], v20 offset:4672
  ds_read_b64_tr_b16 v[172:173], v20 offset:96
  ds_read_b64_tr_b16 v[174:175], v20 offset:4704
  ds_read_b64_tr_b16 v[176:177], v20 offset:128
  ds_read_b64_tr_b16 v[178:179], v20 offset:4736
L1_loop0:
  s_add_u32 s56, s56, 1
  s_cmp_eq_u32 s56, 4
  s_cselect_b32 s56, 0, s56
  s_cselect_b32 s55, 4294875136, s54
  s_waitcnt lgkmcnt(0)
  v_mfma_f32_16x16x32_bf16 v[28:31], v[160:163], v[180:183], v[28:31]
  ds_read_b64_tr_b16 v[192:193], v20 offset:9216
  ds_read_b64_tr_b16 v[194:195], v20 offset:13824
  v_mfma_f32_16x16x32_bf16 v[32:35], v[160:163], v[184:187], v[32:35]
  ds_read_b64_tr_b16 v[212:213], v22 offset:24576
  ds_read_b64_tr_b16 v[214:215], v22 offset:27648
  v_mfma_f32_16x16x32_bf16 v[36:39], v[160:163], v[188:191], v[36:39]
  ds_read_b64_tr_b16 v[216:217], v23 offset:24576
  ds_read_b64_tr_b16 v[218:219], v23 offset:27648
  v_mfma_f32_16x16x32_bf16 v[40:43], v[164:167], v[180:183], v[40:43]
  ds_read_b64_tr_b16 v[220:221], v24 offset:24576
  ds_read_b64_tr_b16 v[222:223], v24 offset:27648
  v_mfma_f32_16x16x32_bf16 v[44:47], v[164:167], v[184:187], v[44:47]
  ds_read_b64_tr_b16 v[196:197], v20 offset:9248
  ds_read_b64_tr_b16 v[198:199], v20 offset:13856
  v_mfma_f32_16x16x32_bf16 v[48:51], v[164:167], v[188:191], v[48:51]
  ds_read_b64_tr_b16 v[200:201], v20 offset:9280
  ds_read_b64_tr_b16 v[202:203], v20 offset:13888
  v_mfma_f32_16x16x32_bf16 v[52:55], v[168:171], v[180:183], v[52:55]
  ds_read_b64_tr_b16 v[204:205], v20 offset:9312
  ds_read_b64_tr_b16 v[206:207], v20 offset:13920
  v_mfma_f32_16x16x32_bf16 v[56:59], v[168:171], v[184:187], v[56:59]
  ds_read_b64_tr_b16 v[208:209], v20 offset:9344
  ds_read_b64_tr_b16 v[210:211], v20 offset:13952
  v_mfma_f32_16x16x32_bf16 v[60:63], v[168:171], v[188:191], v[60:63]
  v_add_u32 v20, s55, v20
  v_add_u32 v22, s55, v22
  v_mfma_f32_16x16x32_bf16 v[64:67], v[172:175], v[180:183], v[64:67]
  v_add_u32 v23, s55, v23
  v_add_u32 v24, s55, v24
  v_mfma_f32_16x16x32_bf16 v[68:71], v[172:175], v[184:187], v[68:71]
  v_mfma_f32_16x16x32_bf16 v[72:75], v[172:175], v[188:191], v[72:75]
  v_mfma_f32_16x16x32_bf16 v[76:79], v[176:179], v[180:183], v[76:79]
  v_mfma_f32_16x16x32_bf16 v[80:83], v[176:179], v[184:187], v[80:83]
  v_mfma_f32_16x16x32_bf16 v[84:87], v[176:179], v[188:191], v[84:87]
  s_waitcnt lgkmcnt(0)
  s_barrier
  v_mfma_f32_16x16x32_bf16 v[28:31], v[192:195], v[212:215], v[28:31]
  ds_read_b64_tr_b16 v[160:161], v20 offset:0
  ds_read_b64_tr_b16 v[162:163], v20 offset:4608
  v_mfma_f32_16x16x32_bf16 v[32:35], v[192:195], v[216:219], v[32:35]
  ds_read_b64_tr_b16 v[180:181], v22 offset:18432
  ds_read_b64_tr_b16 v[182:183], v22 offset:21504
  v_mfma_f32_16x16x32_bf16 v[36:39], v[192:195], v[220:223], v[36:39]
  ds_read_b64_tr_b16 v[184:185], v23 offset:18432
  ds_read_b64_tr_b16 v[186:187], v23 offset:21504
  v_mfma_f32_16x16x32_bf16 v[40:43], v[196:199], v[212:215], v[40:43]
  ds_read_b64_tr_b16 v[188:189], v24 offset:18432
  ds_read_b64_tr_b16 v[190:191], v24 offset:21504
  v_mfma_f32_16x16x32_bf16 v[44:47], v[196:199], v[216:219], v[44:47]
  ds_read_b64_tr_b16 v[164:165], v20 offset:32
  ds_read_b64_tr_b16 v[166:167], v20 offset:4640
  v_mfma_f32_16x16x32_bf16 v[48:51], v[196:199], v[220:223], v[48:51]
  ds_read_b64_tr_b16 v[168:169], v20 offset:64
  ds_read_b64_tr_b16 v[170:171], v20 offset:4672
  v_mfma_f32_16x16x32_bf16 v[52:55], v[200:203], v[212:215], v[52:55]
  ds_read_b64_tr_b16 v[172:173], v20 offset:96
  ds_read_b64_tr_b16 v[174:175], v20 offset:4704
  v_mfma_f32_16x16x32_bf16 v[56:59], v[200:203], v[216:219], v[56:59]
  ds_read_b64_tr_b16 v[176:177], v20 offset:128
  ds_read_b64_tr_b16 v[178:179], v20 offset:4736
  v_mfma_f32_16x16x32_bf16 v[60:63], v[200:203], v[220:223], v[60:63]
  v_mfma_f32_16x16x32_bf16 v[64:67], v[204:207], v[212:215], v[64:67]
  v_mfma_f32_16x16x32_bf16 v[68:71], v[204:207], v[216:219], v[68:71]
  v_mfma_f32_16x16x32_bf16 v[72:75], v[204:207], v[220:223], v[72:75]
  v_mfma_f32_16x16x32_bf16 v[76:79], v[208:211], v[212:215], v[76:79]
  v_mfma_f32_16x16x32_bf16 v[80:83], v[208:211], v[216:219], v[80:83]
  v_mfma_f32_16x16x32_bf16 v[84:87], v[208:211], v[220:223], v[84:87]
  s_add_u32 s57, s57, 1
  s_cmp_lt_u32 s57, 32
  s_cbranch_scc1 L1_loop0
  s_branch L1_mdone
L1_m1:
  ds_read_b64_tr_b16 v[164:165], v20 offset:32
  ds_read_b64_tr_b16 v[166:167], v20 offset:4640
  ds_read_b64_tr_b16 v[180:181], v22 offset:18432
  ds_read_b64_tr_b16 v[182:183], v22 offset:21504
  ds_read_b64_tr_b16 v[184:185], v23 offset:18432
  ds_read_b64_tr_b16 v[186:187], v23 offset:21504
  ds_read_b64_tr_b16 v[188:189], v24 offset:18432
  ds_read_b64_tr_b16 v[190:191], v24 offset:21504
  ds_read_b64_tr_b16 v[168:169], v20 offset:64
  ds_read_b64_tr_b16 v[170:171], v20 offset:4672
  ds_read_b64_tr_b16 v[172:173], v20 offset:96
  ds_read_b64_tr_b16 v[174:175], v20 offset:4704
  ds_read_b64_tr_b16 v[176:177], v20 offset:128
  ds_read_b64_tr_b16 v[178:179], v20 offset:4736
L1_loop1:
  s_add_u32 s56, s56, 1
  s_cmp_eq_u32 s56, 4
  s_cselect_b32 s56, 0, s56
  s_cselect_b32 s55, 4294875136, s54
  s_waitcnt lgkmcnt(0)
  v_mfma_f32_16x16x32_bf16 v[40:43], v[164:167], v[180:183], v[40:43]
  ds_read_b64_tr_b16 v[196:197], v20 offset:9248
  ds_read_b64_tr_b16 v[198:199], v20 offset:13856
  v_mfma_f32_16x16x32_bf16 v[44:47], v[164:167], v[184:187], v[44:47]
  ds_read_b64_tr_b16 v[212:213], v22 offset:24576
  ds_read_b64_tr_b16 v[214:215], v22 offset:27648
  v_mfma_f32_16x16x32_bf16 v[48:51], v[164:167], v[188:191], v[48:51]
  ds_read_b64_tr_b16 v[216:217], v23 offset:24576
  ds_read_b64_tr_b16 v[218:219], v23 offset:27648
  v_mfma_f32_16x16x32_bf16 v[52:55], v[168:171], v[180:183], v[52:55]
  ds_read_b64_tr_b16 v[220:221], v24 offset:24576
  ds_read_b64_tr_b16 v[222:223], v24 offset:27648
  v_mfma_f32_16x16x32_bf16 v[56:59], v[168:171], v[184:187], v[56:59]
  ds_read_b64_tr_b16 v[200:201], v20 offset:9280
  ds_read_b64_tr_b16 v[202:203], v20 offset:13888
  v_mfma_f32_16x16x32_bf16 v[60:63], v[168:171], v[188:191], v[60:63]
  ds_read_b64_tr_b16 v[204:205], v20 offset:9312
  ds_read_b64_tr_b16 v[206:207], v20 offset:13920
  v_mfma_f32_16x16x32_bf16 v[64:67], v[172:175], v[180:183], v[64:67]
  ds_read_b64_tr_b16 v[208:209], v20 offset:9344
  ds_read_b64_tr_b16 v[210:211], v20 offset:13952
  v_mfma_f32_16x16x32_bf16 v[68:71], v[172:175], v[184:187], v[68:71]
  v_add_u32 v20, s55, v20
  v_add_u32 v22, s55, v22
  v_mfma_f32_16x16x32_bf16 v[72:75], v[172:175], v[188:191], v[72:75]
  v_add_u32 v23, s55, v23
  v_add_u32 v24, s55, v24
  v_mfma_f32_16x16x32_bf16 v[76:79], v[176:179], v[180:183], v[76:79]
  v_mfma_f32_16x16x32_bf16 v[80:83], v[176:179], v[184:187], v[80:83]
  v_mfma_f32_16x16x32_bf16 v[84:87], v[176:179], v[188:191], v[84:87]
  s_waitcnt lgkmcnt(0)
  s_barrier
  v_mfma_f32_16x16x32_bf16 v[40:43], v[196:199], v[212:215], v[40:43]
  ds_read_b64_tr_b16 v[164:165], v20 offset:32
  ds_read_b64_tr_b16 v[166:167], v20 offset:4640
  v_mfma_f32_16x16x32_bf16 v[44:47], v[196:199], v[216:219], v[44:47]
  ds_read_b64_tr_b16 v[180:181], v22 offset:18432
  ds_read_b64_tr_b16 v[182:183], v22 offset:21504
  v_mfma_f32_16x16x32_bf16 v[48:51], v[196:199], v[220:223], v[48:51]
  ds_read_b64_tr_b16 v[184:185], v23 offset:18432
  ds_read_b64_tr_b16 v[186:187], v23 offset:21504
  v_mfma_f32_16x16x32_bf16 v[52:55], v[200:203], v[212:215], v[52:55]
  ds_read_b64_tr_b16 v[188:189], v24 offset:18432
  ds_read_b64_tr_b16 v[190:191], v24 offset:21504
  v_mfma_f32_16x16x32_bf16 v[56:59], v[200:203], v[216:219], v[56:59]
  ds_read_b64_tr_b16 v[168:169], v20 offset:64
  ds_read_b64_tr_b16 v[170:171], v20 offset:4672
  v_mfma_f32_16x16x32_bf16 v[60:63], v[200:203], v[220:223], v[60:63]
  ds_read_b64_tr_b16 v[172:173], v20 offset:96
  ds_read_b64_tr_b16 v[174:175], v20 offset:4704
  v_mfma_f32_16x16x32_bf16 v[64:67], v[204:207], v[212:215], v[64:67]
  ds_read_b64_tr_b16 v[176:177], v20 offset:128
  ds_read_b64_tr_b16 v[178:179], v20 offset:4736
  v_mfma_f32_16x16x32_bf16 v[68:71], v[204:207], v[216:219], v[68:71]
  v_mfma_f32_16x16x32_bf16 v[72:75], v[204:207], v[220:223], v[72:75]
  v_mfma_f32_16x16x32_bf16 v[76:79], v[208:211], v[212:215], v[76:79]
  v_mfma_f32_16x16x32_bf16 v[80:83], v[208:211], v[216:219], v[80:83]
  v_mfma_f32_16x16x32_bf16 v[84:87], v[208:211], v[220:223], v[84:87]
  s_add_u32 s57, s57, 1
  s_cmp_lt_u32 s57, 32
  s_cbranch_scc1 L1_loop1
L1_mdone:
  s_nop 4
  s_cmp_eq_u32 s42, 1
  s_cbranch_scc1 Lskip_7
  v_pk_mul_f32 v[100:101], v[28:29], v[28:29]
  v_pk_mul_f32 v[102:103], v[30:31], v[30:31]
  v_pk_mul_f32 v[104:105], v[32:33], v[32:33]
  v_pk_mul_f32 v[106:107], v[34:35], v[34:35]
  v_pk_mul_f32 v[108:109], v[36:37], v[36:37]
  v_pk_mul_f32 v[110:111], v[38:39], v[38:39]
  v_pk_fma_f32 v[100:101], v[100:101], v[158:159], v[156:157]
  v_pk_fma_f32 v[102:103], v[102:103], v[158:159], v[156:157]
  v_pk_fma_f32 v[104:105], v[104:105], v[158:159], v[156:157]
  v_pk_fma_f32 v[106:107], v[106:107], v[158:159], v[156:157]
  v_pk_fma_f32 v[108:109], v[108:109], v[158:159], v[156:157]
  v_pk_fma_f32 v[110:111], v[110:111], v[158:159], v[156:157]
  v_pk_mul_f32 v[100:101], v[100:101], v[28:29]
  v_pk_mul_f32 v[102:103], v[102:103], v[30:31]
  v_pk_mul_f32 v[104:105], v[104:105], v[32:33]
  v_pk_mul_f32 v[106:107], v[106:107], v[34:35]
  v_pk_mul_f32 v[108:109], v[108:109], v[36:37]
  v_pk_mul_f32 v[110:111], v[110:111], v[38:39]
  v_exp_f32 v100, v100
  v_exp_f32 v101, v101
  v_exp_f32 v102, v102
  v_exp_f32 v103, v103
  v_exp_f32 v104, v104
  v_exp_f32 v105, v105
  v_exp_f32 v106, v106
  v_exp_f32 v107, v107
  v_exp_f32 v108, v108
  v_exp_f32 v109, v109
  v_exp_f32 v110, v110
  v_exp_f32 v111, v111
  v_pk_add_f32 v[100:101], v[100:101], v[146:147]
  v_pk_add_f32 v[102:103], v[102:103], v[146:147]
  v_pk_add_f32 v[104:105], v[104:105], v[146:147]
  v_pk_add_f32 v[106:107], v[106:107], v[146:147]
  v_pk_add_f32 v[108:109], v[108:109], v[146:147]
  v_pk_add_f32 v[110:111], v[110:111], v[146:147]
  v_rcp_f32 v100, v100
  v_rcp_f32 v101, v101
  v_rcp_f32 v102, v102
  v_rcp_f32 v103, v103
  v_rcp_f32 v104, v104
  v_rcp_f32 v105, v105
  v_rcp_f32 v106, v106
  v_rcp_f32 v107, v107
  v_rcp_f32 v108, v108
  v_rcp_f32 v109, v109
  v_rcp_f32 v110, v110
  v_rcp_f32 v111, v111
  v_pk_mul_f32 v[28:29], v[28:29], v[100:101]
  v_pk_mul_f32 v[30:31], v[30:31], v[102:103]
  v_pk_mul_f32 v[32:33], v[32:33], v[104:105]
  v_pk_mul_f32 v[34:35], v[34:35], v[106:107]
  v_pk_mul_f32 v[36:37], v[36:37], v[108:109]
  v_pk_mul_f32 v[38:39], v[38:39], v[110:111]
  v_cvt_pk_bf16_f32 v28, v28, v29
  v_cvt_pk_bf16_f32 v29, v30, v31
  buffer_store_dwordx2 v[28:29], v148, s[28:31], s44 offen offset:0 sc1
  v_cvt_pk_bf16_f32 v32, v32, v33
  v_cvt_pk_bf16_f32 v33, v34, v35
  buffer_store_dwordx2 v[32:33], v148, s[28:31], s45 offen offset:0 sc1
  v_cvt_pk_bf16_f32 v36, v36, v37
  v_cvt_pk_bf16_f32 v37, v38, v39
  buffer_store_dwordx2 v[36:37], v148, s[28:31], s46 offen offset:0 sc1
Lskip_7:
  v_pk_mul_f32 v[100:101], v[40:41], v[40:41]
  v_pk_mul_f32 v[102:103], v[42:43], v[42:43]
  v_pk_mul_f32 v[104:105], v[44:45], v[44:45]
  v_pk_mul_f32 v[106:107], v[46:47], v[46:47]
  v_pk_mul_f32 v[108:109], v[48:49], v[48:49]
  v_pk_mul_f32 v[110:111], v[50:51], v[50:51]
  v_pk_fma_f32 v[100:101], v[100:101], v[158:159], v[156:157]
  v_pk_fma_f32 v[102:103], v[102:103], v[158:159], v[156:157]
  v_pk_fma_f32 v[104:105], v[104:105], v[158:159], v[156:157]
  v_pk_fma_f32 v[106:107], v[106:107], v[158:159], v[156:157]
  v_pk_fma_f32 v[108:109], v[108:109], v[158:159], v[156:157]
  v_pk_fma_f32 v[110:111], v[110:111], v[158:159], v[156:157]
  v_pk_mul_f32 v[100:101], v[100:101], v[40:41]
  v_pk_mul_f32 v[102:103], v[102:103], v[42:43]
  v_pk_mul_f32 v[104:105], v[104:105], v[44:45]
  v_pk_mul_f32 v[106:107], v[106:107], v[46:47]
  v_pk_mul_f32 v[108:109], v[108:109], v[48:49]
  v_pk_mul_f32 v[110:111], v[110:111], v[50:51]
  v_exp_f32 v100, v100
  v_exp_f32 v101, v101
  v_exp_f32 v102, v102
  v_exp_f32 v103, v103
  v_exp_f32 v104, v104
  v_exp_f32 v105, v105
  v_exp_f32 v106, v106
  v_exp_f32 v107, v107
  v_exp_f32 v108, v108
  v_exp_f32 v109, v109
  v_exp_f32 v110, v110
  v_exp_f32 v111, v111
  v_pk_add_f32 v[100:101], v[100:101], v[146:147]
  v_pk_add_f32 v[102:103], v[102:103], v[146:147]
  v_pk_add_f32 v[104:105], v[104:105], v[146:147]
  v_pk_add_f32 v[106:107], v[106:107], v[146:147]
  v_pk_add_f32 v[108:109], v[108:109], v[146:147]
  v_pk_add_f32 v[110:111], v[110:111], v[146:147]
  v_rcp_f32 v100, v100
  v_rcp_f32 v101, v101
  v_rcp_f32 v102, v102
  v_rcp_f32 v103, v103
  v_rcp_f32 v104, v104
  v_rcp_f32 v105, v105
  v_rcp_f32 v106, v106
  v_rcp_f32 v107, v107
  v_rcp_f32 v108, v108
  v_rcp_f32 v109, v109
  v_rcp_f32 v110, v110
  v_rcp_f32 v111, v111
  v_pk_mul_f32 v[40:41], v[40:41], v[100:101]
  v_pk_mul_f32 v[42:43], v[42:43], v[102:103]
  v_pk_mul_f32 v[44:45], v[44:45], v[104:105]
  v_pk_mul_f32 v[46:47], v[46:47], v[106:107]
  v_pk_mul_f32 v[48:49], v[48:49], v[108:109]
  v_pk_mul_f32 v[50:51], v[50:51], v[110:111]
  v_cvt_pk_bf16_f32 v40, v40, v41
  v_cvt_pk_bf16_f32 v41, v42, v43
  buffer_store_dwordx2 v[40:41], v148, s[28:31], s44 offen offset:512 sc1
  v_cvt_pk_bf16_f32 v44, v44, v45
  v_cvt_pk_bf16_f32 v45, v46, v47
  buffer_store_dwordx2 v[44:45], v148, s[28:31], s45 offen offset:512 sc1
  v_cvt_pk_bf16_f32 v48, v48, v49
  v_cvt_pk_bf16_f32 v49, v50, v51
  buffer_store_dwordx2 v[48:49], v148, s[28:31], s46 offen offset:512 sc1
  v_pk_mul_f32 v[100:101], v[52:53], v[52:53]
  v_pk_mul_f32 v[102:103], v[54:55], v[54:55]
  v_pk_mul_f32 v[104:105], v[56:57], v[56:57]
  v_pk_mul_f32 v[106:107], v[58:59], v[58:59]
  v_pk_mul_f32 v[108:109], v[60:61], v[60:61]
  v_pk_mul_f32 v[110:111], v[62:63], v[62:63]
  v_pk_fma_f32 v[100:101], v[100:101], v[158:159], v[156:157]
  v_pk_fma_f32 v[102:103], v[102:103], v[158:159], v[156:157]
  v_pk_fma_f32 v[104:105], v[104:105], v[158:159], v[156:157]
  v_pk_fma_f32 v[106:107], v[106:107], v[158:159], v[156:157]
  v_pk_fma_f32 v[108:109], v[108:109], v[158:159], v[156:157]
  v_pk_fma_f32 v[110:111], v[110:111], v[158:159], v[156:157]
  v_pk_mul_f32 v[100:101], v[100:101], v[52:53]
  v_pk_mul_f32 v[102:103], v[102:103], v[54:55]
  v_pk_mul_f32 v[104:105], v[104:105], v[56:57]
  v_pk_mul_f32 v[106:107], v[106:107], v[58:59]
  v_pk_mul_f32 v[108:109], v[108:109], v[60:61]
  v_pk_mul_f32 v[110:111], v[110:111], v[62:63]
  v_exp_f32 v100, v100
  v_exp_f32 v101, v101
  v_exp_f32 v102, v102
  v_exp_f32 v103, v103
  v_exp_f32 v104, v104
  v_exp_f32 v105, v105
  v_exp_f32 v106, v106
  v_exp_f32 v107, v107
  v_exp_f32 v108, v108
  v_exp_f32 v109, v109
  v_exp_f32 v110, v110
  v_exp_f32 v111, v111
  v_pk_add_f32 v[100:101], v[100:101], v[146:147]
  v_pk_add_f32 v[102:103], v[102:103], v[146:147]
  v_pk_add_f32 v[104:105], v[104:105], v[146:147]
  v_pk_add_f32 v[106:107], v[106:107], v[146:147]
  v_pk_add_f32 v[108:109], v[108:109], v[146:147]
  v_pk_add_f32 v[110:111], v[110:111], v[146:147]
  v_rcp_f32 v100, v100
  v_rcp_f32 v101, v101
  v_rcp_f32 v102, v102
  v_rcp_f32 v103, v103
  v_rcp_f32 v104, v104
  v_rcp_f32 v105, v105
  v_rcp_f32 v106, v106
  v_rcp_f32 v107, v107
  v_rcp_f32 v108, v108
  v_rcp_f32 v109, v109
  v_rcp_f32 v110, v110
  v_rcp_f32 v111, v111
  v_pk_mul_f32 v[52:53], v[52:53], v[100:101]
  v_pk_mul_f32 v[54:55], v[54:55], v[102:103]
  v_pk_mul_f32 v[56:57], v[56:57], v[104:105]
  v_pk_mul_f32 v[58:59], v[58:59], v[106:107]
  v_pk_mul_f32 v[60:61], v[60:61], v[108:109]
  v_pk_mul_f32 v[62:63], v[62:63], v[110:111]
  v_cvt_pk_bf16_f32 v52, v52, v53
  v_cvt_pk_bf16_f32 v53, v54, v55
  buffer_store_dwordx2 v[52:53], v148, s[28:31], s44 offen offset:1024 sc1
  v_cvt_pk_bf16_f32 v56, v56, v57
  v_cvt_pk_bf16_f32 v57, v58, v59
  buffer_store_dwordx2 v[56:57], v148, s[28:31], s45 offen offset:1024 sc1
  v_cvt_pk_bf16_f32 v60, v60, v61
  v_cvt_pk_bf16_f32 v61, v62, v63
  buffer_store_dwordx2 v[60:61], v148, s[28:31], s46 offen offset:1024 sc1
  v_pk_mul_f32 v[100:101], v[64:65], v[64:65]
  v_pk_mul_f32 v[102:103], v[66:67], v[66:67]
  v_pk_mul_f32 v[104:105], v[68:69], v[68:69]
  v_pk_mul_f32 v[106:107], v[70:71], v[70:71]
  v_pk_mul_f32 v[108:109], v[72:73], v[72:73]
  v_pk_mul_f32 v[110:111], v[74:75], v[74:75]
  v_pk_fma_f32 v[100:101], v[100:101], v[158:159], v[156:157]
  v_pk_fma_f32 v[102:103], v[102:103], v[158:159], v[156:157]
  v_pk_fma_f32 v[104:105], v[104:105], v[158:159], v[156:157]
  v_pk_fma_f32 v[106:107], v[106:107], v[158:159], v[156:157]
  v_pk_fma_f32 v[108:109], v[108:109], v[158:159], v[156:157]
  v_pk_fma_f32 v[110:111], v[110:111], v[158:159], v[156:157]
  v_pk_mul_f32 v[100:101], v[100:101], v[64:65]
  v_pk_mul_f32 v[102:103], v[102:103], v[66:67]
  v_pk_mul_f32 v[104:105], v[104:105], v[68:69]
  v_pk_mul_f32 v[106:107], v[106:107], v[70:71]
  v_pk_mul_f32 v[108:109], v[108:109], v[72:73]
  v_pk_mul_f32 v[110:111], v[110:111], v[74:75]
  v_exp_f32 v100, v100
  v_exp_f32 v101, v101
  v_exp_f32 v102, v102
  v_exp_f32 v103, v103
  v_exp_f32 v104, v104
  v_exp_f32 v105, v105
  v_exp_f32 v106, v106
  v_exp_f32 v107, v107
  v_exp_f32 v108, v108
  v_exp_f32 v109, v109
  v_exp_f32 v110, v110
  v_exp_f32 v111, v111
  v_pk_add_f32 v[100:101], v[100:101], v[146:147]
  v_pk_add_f32 v[102:103], v[102:103], v[146:147]
  v_pk_add_f32 v[104:105], v[104:105], v[146:147]
  v_pk_add_f32 v[106:107], v[106:107], v[146:147]
  v_pk_add_f32 v[108:109], v[108:109], v[146:147]
  v_pk_add_f32 v[110:111], v[110:111], v[146:147]
  v_rcp_f32 v100, v100
  v_rcp_f32 v101, v101
  v_rcp_f32 v102, v102
  v_rcp_f32 v103, v103
  v_rcp_f32 v104, v104
  v_rcp_f32 v105, v105
  v_rcp_f32 v106, v106
  v_rcp_f32 v107, v107
  v_rcp_f32 v108, v108
  v_rcp_f32 v109, v109
  v_rcp_f32 v110, v110
  v_rcp_f32 v111, v111
  v_pk_mul_f32 v[64:65], v[64:65], v[100:101]
  v_pk_mul_f32 v[66:67], v[66:67], v[102:103]
  v_pk_mul_f32 v[68:69], v[68:69], v[104:105]
  v_pk_mul_f32 v[70:71], v[70:71], v[106:107]
  v_pk_mul_f32 v[72:73], v[72:73], v[108:109]
  v_pk_mul_f32 v[74:75], v[74:75], v[110:111]
  v_cvt_pk_bf16_f32 v64, v64, v65
  v_cvt_pk_bf16_f32 v65, v66, v67
  buffer_store_dwordx2 v[64:65], v148, s[28:31], s44 offen offset:1536 sc1
  v_cvt_pk_bf16_f32 v68, v68, v69
  v_cvt_pk_bf16_f32 v69, v70, v71
  buffer_store_dwordx2 v[68:69], v148, s[28:31], s45 offen offset:1536 sc1
  v_cvt_pk_bf16_f32 v72, v72, v73
  v_cvt_pk_bf16_f32 v73, v74, v75
  buffer_store_dwordx2 v[72:73], v148, s[28:31], s46 offen offset:1536 sc1
  v_pk_mul_f32 v[100:101], v[76:77], v[76:77]
  v_pk_mul_f32 v[102:103], v[78:79], v[78:79]
  v_pk_mul_f32 v[104:105], v[80:81], v[80:81]
  v_pk_mul_f32 v[106:107], v[82:83], v[82:83]
  v_pk_mul_f32 v[108:109], v[84:85], v[84:85]
  v_pk_mul_f32 v[110:111], v[86:87], v[86:87]
  v_pk_fma_f32 v[100:101], v[100:101], v[158:159], v[156:157]
  v_pk_fma_f32 v[102:103], v[102:103], v[158:159], v[156:157]
  v_pk_fma_f32 v[104:105], v[104:105], v[158:159], v[156:157]
  v_pk_fma_f32 v[106:107], v[106:107], v[158:159], v[156:157]
  v_pk_fma_f32 v[108:109], v[108:109], v[158:159], v[156:157]
  v_pk_fma_f32 v[110:111], v[110:111], v[158:159], v[156:157]
  v_pk_mul_f32 v[100:101], v[100:101], v[76:77]
  v_pk_mul_f32 v[102:103], v[102:103], v[78:79]
  v_pk_mul_f32 v[104:105], v[104:105], v[80:81]
  v_pk_mul_f32 v[106:107], v[106:107], v[82:83]
  v_pk_mul_f32 v[108:109], v[108:109], v[84:85]
  v_pk_mul_f32 v[110:111], v[110:111], v[86:87]
  v_exp_f32 v100, v100
  v_exp_f32 v101, v101
  v_exp_f32 v102, v102
  v_exp_f32 v103, v103
  v_exp_f32 v104, v104
  v_exp_f32 v105, v105
  v_exp_f32 v106, v106
  v_exp_f32 v107, v107
  v_exp_f32 v108, v108
  v_exp_f32 v109, v109
  v_exp_f32 v110, v110
  v_exp_f32 v111, v111
  v_pk_add_f32 v[100:101], v[100:101], v[146:147]
  v_pk_add_f32 v[102:103], v[102:103], v[146:147]
  v_pk_add_f32 v[104:105], v[104:105], v[146:147]
  v_pk_add_f32 v[106:107], v[106:107], v[146:147]
  v_pk_add_f32 v[108:109], v[108:109], v[146:147]
  v_pk_add_f32 v[110:111], v[110:111], v[146:147]
  v_rcp_f32 v100, v100
  v_rcp_f32 v101, v101
  v_rcp_f32 v102, v102
  v_rcp_f32 v103, v103
  v_rcp_f32 v104, v104
  v_rcp_f32 v105, v105
  v_rcp_f32 v106, v106
  v_rcp_f32 v107, v107
  v_rcp_f32 v108, v108
  v_rcp_f32 v109, v109
  v_rcp_f32 v110, v110
  v_rcp_f32 v111, v111
  v_pk_mul_f32 v[76:77], v[76:77], v[100:101]
  v_pk_mul_f32 v[78:79], v[78:79], v[102:103]
  v_pk_mul_f32 v[80:81], v[80:81], v[104:105]
  v_pk_mul_f32 v[82:83], v[82:83], v[106:107]
  v_pk_mul_f32 v[84:85], v[84:85], v[108:109]
  v_pk_mul_f32 v[86:87], v[86:87], v[110:111]
  v_cvt_pk_bf16_f32 v76, v76, v77
  v_cvt_pk_bf16_f32 v77, v78, v79
  buffer_store_dwordx2 v[76:77], v148, s[28:31], s44 offen offset:2048 sc1
  v_cvt_pk_bf16_f32 v80, v80, v81
  v_cvt_pk_bf16_f32 v81, v82, v83
  buffer_store_dwordx2 v[80:81], v148, s[28:31], s45 offen offset:2048 sc1
  v_cvt_pk_bf16_f32 v84, v84, v85
  v_cvt_pk_bf16_f32 v85, v86, v87
  buffer_store_dwordx2 v[84:85], v148, s[28:31], s46 offen offset:2048 sc1
  s_endpgm
L1_qkv:
  s_lshr_b32 s37, s2, 3
  s_and_b32 s38, s37, 3
  s_lshr_b32 s37, s37, 2
  s_and_b32 s36, s2, 1
  s_lshl_b32 s36, s36, 3
  s_add_u32 s36, s36, s37
  v_lshrrev_b32 v2, 6, v0
  v_and_b32 v1, 63, v0
  v_readfirstlane_b32 s18, v2
  v_lshrrev_b32 v2, 4, v1
  v_and_b32 v3, 15, v1
  v_lshrrev_b32 v4, 2, v3
  v_and_b32 v5, 3, v3
  s_waitcnt lgkmcnt(0)
  s_cmp_lt_u32 s18, 4
  s_cbranch_scc1 L1_qc
  s_add_u32 s24, s8, 6291456
  s_addc_u32 s25, s9, 0
  s_mov_b32 s26, 1990656
  s_mov_b32 s27, 0x20000
  s_sub_u32 s19, s18, 4
  s_mul_i32 s52, s38, 497664
  s_add_u32 s26, s52, 497664
  s_mul_i32 s45, s19, 5
  s_lshl_b32 s46, s19, 2
  s_add_u32 s46, s46, 2
  s_cmp_lt_u32 s19, 2
  s_cselect_b32 s45, s45, s46
  s_lshl_b32 s47, s45, 10
  v_lshl_add_u32 v10, v1, 4, s47
  v_add_u32 v11, 4096, v10
  s_sub_u32 s52, s52, 18432
  s_cmp_lt_u32 s19, 2
  s_cbranch_scc1 L1_ql5
  s_mov_b32 s53, 0
  s_add_u32 s52, s52, 18432
  s_add_u32 s64, s53, s47
  s_mov_b32 s57, 0
Lldq4_8:
  s_mov_b32 m0, s64
  s_nop 0
  buffer_load_dwordx4 v10, s[24:27], s52 offen offset:0 lds
  buffer_load_dwordx4 v10, s[24:27], s52 offen offset:1024 lds
  buffer_load_dwordx4 v10, s[24:27], s52 offen offset:2048 lds
  buffer_load_dwordx4 v10, s[24:27], s52 offen offset:3072 lds
  s_add_u32 s53, s53, 18432
  s_cmp_eq_u32 s53, 110592
  s_cselect_b32 s53, 0, s53
  s_add_u32 s52, s52, 18432
  s_add_u32 s64, s53, s47
  s_add_u32 s57, s57, 1
  s_cmp_lg_u32 s57, 2
  s_cbranch_scc1 Lldq4_10
  s_waitcnt vmcnt(4)
  s_barrier
Lldq4_10:
  s_cmp_lt_u32 s57, 6
  s_cbranch_scc1 Lldq4_8
Lldq4_9:
  s_waitcnt vmcnt(16)
  s_barrier
  s_mov_b32 m0, s64
  s_nop 0
  buffer_load_dwordx4 v10, s[24:27], s52 offen offset:0 lds
  buffer_load_dwordx4 v10, s[24:27], s52 offen offset:1024 lds
  buffer_load_dwordx4 v10, s[24:27], s52 offen offset:2048 lds
  buffer_load_dwordx4 v10, s[24:27], s52 offen offset:3072 lds
  s_add_u32 s53, s53, 18432
  s_cmp_eq_u32 s53, 110592
  s_cselect_b32 s53, 0, s53
  s_add_u32 s52, s52, 18432
  s_add_u32 s64, s53, s47
  s_add_u32 s57, s57, 1
  s_cmp_lt_u32 s57, 27
  s_cbranch_scc1 Lldq4_9
  s_waitcnt vmcnt(16)
  s_barrier
  s_waitcnt vmcnt(12)
  s_barrier
  s_waitcnt vmcnt(8)
  s_barrier
  s_waitcnt vmcnt(4)
  s_barrier
  s_waitcnt vmcnt(0)
  s_barrier
  s_waitcnt vmcnt(0)
  s_barrier
  s_endpgm
L1_ql5:
  s_mov_b32 s53, 0
  s_add_u32 s52, s52, 18432
  s_add_u32 s64, s53, s47
  s_mov_b32 s57, 0
Lldq5_11:
  s_mov_b32 m0, s64
  s_nop 0
  buffer_load_dwordx4 v10, s[24:27], s52 offen offset:0 lds
  buffer_load_dwordx4 v10, s[24:27], s52 offen offset:1024 lds
  buffer_load_dwordx4 v10, s[24:27], s52 offen offset:2048 lds
  buffer_load_dwordx4 v10, s[24:27], s52 offen offset:3072 lds
  s_add_u32 m0, m0, 4096
  s_nop 0
  buffer_load_dwordx4 v11, s[24:27], s52 offen lds
  s_add_u32 s53, s53, 18432
  s_cmp_eq_u32 s53, 110592
  s_cselect_b32 s53, 0, s53
  s_add_u32 s52, s52, 18432
  s_add_u32 s64, s53, s47
  s_add_u32 s57, s57, 1
  s_cmp_lg_u32 s57, 2
  s_cbranch_scc1 Lldq5_13
  s_waitcnt vmcnt(5)
  s_barrier
Lldq5_13:
  s_cmp_lt_u32 s57, 6
  s_cbranch_scc1 Lldq5_11
Lldq5_12:
  s_waitcnt vmcnt(20)
  s_barrier
  s_mov_b32 m0, s64
  s_nop 0
  buffer_load_dwordx4 v10, s[24:27], s52 offen offset:0 lds
  buffer_load_dwordx4 v10, s[24:27], s52 offen offset:1024 lds
  buffer_load_dwordx4 v10, s[24:27], s52 offen offset:2048 lds
  buffer_load_dwordx4 v10, s[24:27], s52 offen offset:3072 lds
  s_add_u32 m0, m0, 4096
  s_nop 0
  buffer_load_dwordx4 v11, s[24:27], s52 offen lds
  s_add_u32 s53, s53, 18432
  s_cmp_eq_u32 s53, 110592
  s_cselect_b32 s53, 0, s53
  s_add_u32 s52, s52, 18432
  s_add_u32 s64, s53, s47
  s_add_u32 s57, s57, 1
  s_cmp_lt_u32 s57, 27
  s_cbranch_scc1 Lldq5_12
  s_waitcnt vmcnt(20)
  s_barrier
  s_waitcnt vmcnt(15)
  s_barrier
  s_waitcnt vmcnt(10)
  s_barrier
  s_waitcnt vmcnt(5)
  s_barrier
  s_waitcnt vmcnt(0)
  s_barrier
  s_waitcnt vmcnt(0)
  s_barrier
  s_endpgm
L1_qc:
  s_mov_b32 s20, s8
  s_mov_b32 s21, s9
  s_mov_b32 s22, 2359296
  s_mov_b32 s23, 0x20000
  s_lshl_b32 s41, s36, 2
  s_add_u32 s41, s41, s18
  s_mul_i32 s39, s41, 36864
  v_lshlrev_b32 v6, 4, v1
  s_add_u32 s42, s39, 0
  s_add_u32 s43, s39, 18432
  buffer_load_dwordx4 v[112:115], v6, s[20:23], s42 offen offset:0
  buffer_load_dwordx4 v[116:119], v6, s[20:23], s43 offen offset:0
  buffer_load_dwordx4 v[120:123], v6, s[20:23], s42 offen offset:1024
  buffer_load_dwordx4 v[124:127], v6, s[20:23], s43 offen offset:1024
  buffer_load_dwordx4 v[128:131], v6, s[20:23], s42 offen offset:2048
  buffer_load_dwordx4 v[132:135], v6, s[20:23], s43 offen offset:2048
  buffer_load_dwordx4 v[136:139], v6, s[20:23], s42 offen offset:3072
  buffer_load_dwordx4 v[140:143], v6, s[20:23], s43 offen offset:3072
  s_add_u32 s42, s39, 4096
  s_add_u32 s43, s39, 22528
  buffer_load_dwordx4 v[144:147], v6, s[20:23], s42 offen offset:0
  buffer_load_dwordx4 v[148:151], v6, s[20:23], s43 offen offset:0
  buffer_load_dwordx4 v[152:155], v6, s[20:23], s42 offen offset:1024
  buffer_load_dwordx4 v[156:159], v6, s[20:23], s43 offen offset:1024
  buffer_load_dwordx4 v[160:163], v6, s[20:23], s42 offen offset:2048
  buffer_load_dwordx4 v[164:167], v6, s[20:23], s43 offen offset:2048
  buffer_load_dwordx4 v[168:171], v6, s[20:23], s42 offen offset:3072
  buffer_load_dwordx4 v[172:175], v6, s[20:23], s43 offen offset:3072
  s_add_u32 s42, s39, 8192
  s_add_u32 s43, s39, 26624
  buffer_load_dwordx4 v[176:179], v6, s[20:23], s42 offen offset:0
  buffer_load_dwordx4 v[180:183], v6, s[20:23], s43 offen offset:0
  buffer_load_dwordx4 v[184:187], v6, s[20:23], s42 offen offset:1024
  buffer_load_dwordx4 v[188:191], v6, s[20:23], s43 offen offset:1024
  buffer_load_dwordx4 v[192:195], v6, s[20:23], s42 offen offset:2048
  buffer_load_dwordx4 v[196:199], v6, s[20:23], s43 offen offset:2048
  buffer_load_dwordx4 v[200:203], v6, s[20:23], s42 offen offset:3072
  buffer_load_dwordx4 v[204:207], v6, s[20:23], s43 offen offset:3072
  s_add_u32 s42, s39, 12288
  s_add_u32 s43, s39, 30720
  buffer_load_dwordx4 v[208:211], v6, s[20:23], s42 offen offset:0
  buffer_load_dwordx4 v[212:215], v6, s[20:23], s43 offen offset:0
  buffer_load_dwordx4 v[216:219], v6, s[20:23], s42 offen offset:1024
  buffer_load_dwordx4 v[220:223], v6, s[20:23], s43 offen offset:1024
  buffer_load_dwordx4 v[224:227], v6, s[20:23], s42 offen offset:2048
  buffer_load_dwordx4 v[228:231], v6, s[20:23], s43 offen offset:2048
  buffer_load_dwordx4 v[232:235], v6, s[20:23], s42 offen offset:3072
  buffer_load_dwordx4 v[236:239], v6, s[20:23], s43 offen offset:3072
  s_add_u32 s42, s39, 16384
  s_add_u32 s43, s39, 34816
  buffer_load_dwordx4 v[240:243], v6, s[20:23], s42 offen offset:0
  buffer_load_dwordx4 v[244:247], v6, s[20:23], s43 offen offset:0
  buffer_load_dwordx4 v[248:251], v6, s[20:23], s42 offen offset:1024
  buffer_load_dwordx4 v[252:255], v6, s[20:23], s43 offen offset:1024
  s_add_u32 s28, s8, 9437184
  s_addc_u32 s29, s9, 0
  s_mov_b32 s30, 7077888
  s_mov_b32 s31, 0x20000
  v_lshrrev_b32 v6, 1, v2
  v_lshlrev_b32 v6, 4, v6
  v_and_b32 v7, 1, v2
  v_lshl_add_u32 v6, v7, 2, v6
  v_add_u32 v6, v6, v4
  v_mul_u32_u24 v6, 96, v6
  v_lshl_add_u32 v20, v5, 3, v6
  v_mov_b32 v21, v20
  s_mov_b32 s55, 0
  s_lshl_b32 s42, s41, 10
  v_lshrrev_b32 v6, 1, v2
  v_lshlrev_b32 v6, 9, v6
  v_and_b32 v7, 1, v2
  v_lshl_add_u32 v6, v7, 3, v6
  v_add_u32 v6, s42, v6
  v_lshl_add_u32 v80, v3, 4, v6
  v_bfe_u32 v7, v3, 2, 1
  v_bfe_u32 v8, v3, 3, 1
  v_xor_b32 v7, v7, v8
  v_mul_u32_u24 v7, 12, v7
  v_xor_b32 v7, v7, v3
  v_lshl_add_u32 v84, v7, 4, v6
  s_lshl_b32 s42, s41, 8
  s_lshl_b32 s43, s38, 16
  s_add_u32 s42, s42, s43
  v_lshlrev_b32 v6, 14, v2
  v_add_u32 v6, s42, v6
  v_lshl_add_u32 v82, v3, 3, v6
  v_lshl_add_u32 v86, v7, 3, v6
  s_mul_i32 s42, s41, 1152
  v_lshrrev_b32 v6, 1, v2
  v_mul_u32_u24 v6, 288, v6
  v_and_b32 v7, 1, v2
  v_lshl_add_u32 v6, v7, 3, v6
  v_add_u32 v6, s42, v6
  v_lshl_add_u32 v88, v3, 4, v6
  v_lshrrev_b32 v7, 1, v3
  v_mul_u32_u24 v7, 73728, v7
  v_and_b32 v8, 1, v3
  v_lshl_add_u32 v7, v8, 4, v7
  v_add3_u32 v89, v6, v7, 64
  v_add_u32 v89, 192, v89
  v_mov_b32 v76, 0x3eae1a93
  v_mov_b32 v77, 0x3eae1a93
  s_lshl_b32 s60, s38, 19
  s_mov_b32 s61, 4194304
  s_mov_b32 s62, 0
  s_mov_b32 s57, 0
  s_barrier
  ds_read_b64_tr_b16 v[48:49], v21 offset:0
  ds_read_b64_tr_b16 v[50:51], v21 offset:768
  ds_read_b64_tr_b16 v[52:53], v21 offset:32
  ds_read_b64_tr_b16 v[54:55], v21 offset:800
  ds_read_b64_tr_b16 v[56:57], v21 offset:64
  ds_read_b64_tr_b16 v[58:59], v21 offset:832
L1_qk:
  s_waitcnt vmcnt(34) lgkmcnt(0)
  v_mfma_f32_16x16x32_bf16 v[24:27], v[48:51], v[112:115], 0
  ds_read_b64_tr_b16 v[60:61], v21 offset:3072
  ds_read_b64_tr_b16 v[62:63], v21 offset:3840
  v_mfma_f32_16x16x32_bf16 v[28:31], v[48:51], v[116:119], 0
  ds_read_b64_tr_b16 v[64:65], v21 offset:3104
  ds_read_b64_tr_b16 v[66:67], v21 offset:3872
  v_mfma_f32_16x16x32_bf16 v[32:35], v[52:55], v[112:115], 0
  ds_read_b64_tr_b16 v[68:69], v21 offset:3136
  ds_read_b64_tr_b16 v[70:71], v21 offset:3904
  v_mfma_f32_16x16x32_bf16 v[36:39], v[52:55], v[116:119], 0
  v_mfma_f32_16x16x32_bf16 v[40:43], v[56:59], v[112:115], 0
  v_mfma_f32_16x16x32_bf16 v[44:47], v[56:59], v[116:119], 0
  s_waitcnt vmcnt(32) lgkmcnt(0)
  v_mfma_f32_16x16x32_bf16 v[24:27], v[60:63], v[120:123], v[24:27]
  ds_read_b64_tr_b16 v[48:49], v21 offset:6144
  ds_read_b64_tr_b16 v[50:51], v21 offset:6912
  v_mfma_f32_16x16x32_bf16 v[28:31], v[60:63], v[124:127], v[28:31]
  ds_read_b64_tr_b16 v[52:53], v21 offset:6176
  ds_read_b64_tr_b16 v[54:55], v21 offset:6944
  v_mfma_f32_16x16x32_bf16 v[32:35], v[64:67], v[120:123], v[32:35]
  ds_read_b64_tr_b16 v[56:57], v21 offset:6208
  ds_read_b64_tr_b16 v[58:59], v21 offset:6976
  v_mfma_f32_16x16x32_bf16 v[36:39], v[64:67], v[124:127], v[36:39]
  v_mfma_f32_16x16x32_bf16 v[40:43], v[68:71], v[120:123], v[40:43]
  v_mfma_f32_16x16x32_bf16 v[44:47], v[68:71], v[124:127], v[44:47]
  s_waitcnt vmcnt(30) lgkmcnt(0)
  v_mfma_f32_16x16x32_bf16 v[24:27], v[48:51], v[128:131], v[24:27]
  ds_read_b64_tr_b16 v[60:61], v21 offset:9216
  ds_read_b64_tr_b16 v[62:63], v21 offset:9984
  v_mfma_f32_16x16x32_bf16 v[28:31], v[48:51], v[132:135], v[28:31]
  ds_read_b64_tr_b16 v[64:65], v21 offset:9248
  ds_read_b64_tr_b16 v[66:67], v21 offset:10016
  v_mfma_f32_16x16x32_bf16 v[32:35], v[52:55], v[128:131], v[32:35]
  ds_read_b64_tr_b16 v[68:69], v21 offset:9280
  ds_read_b64_tr_b16 v[70:71], v21 offset:10048
  v_mfma_f32_16x16x32_bf16 v[36:39], v[52:55], v[132:135], v[36:39]
  v_mfma_f32_16x16x32_bf16 v[40:43], v[56:59], v[128:131], v[40:43]
  v_mfma_f32_16x16x32_bf16 v[44:47], v[56:59], v[132:135], v[44:47]
  s_waitcnt vmcnt(28) lgkmcnt(0)
  v_mfma_f32_16x16x32_bf16 v[24:27], v[60:63], v[136:139], v[24:27]
  ds_read_b64_tr_b16 v[48:49], v21 offset:12288
  ds_read_b64_tr_b16 v[50:51], v21 offset:13056
  v_mfma_f32_16x16x32_bf16 v[28:31], v[60:63], v[140:143], v[28:31]
  ds_read_b64_tr_b16 v[52:53], v21 offset:12320
  ds_read_b64_tr_b16 v[54:55], v21 offset:13088
  v_mfma_f32_16x16x32_bf16 v[32:35], v[64:67], v[136:139], v[32:35]
  ds_read_b64_tr_b16 v[56:57], v21 offset:12352
  ds_read_b64_tr_b16 v[58:59], v21 offset:13120
  v_mfma_f32_16x16x32_bf16 v[36:39], v[64:67], v[140:143], v[36:39]
  v_mfma_f32_16x16x32_bf16 v[40:43], v[68:71], v[136:139], v[40:43]
  v_mfma_f32_16x16x32_bf16 v[44:47], v[68:71], v[140:143], v[44:47]
  s_waitcnt vmcnt(26) lgkmcnt(0)
  v_mfma_f32_16x16x32_bf16 v[24:27], v[48:51], v[144:147], v[24:27]
  ds_read_b64_tr_b16 v[60:61], v21 offset:15360
  ds_read_b64_tr_b16 v[62:63], v21 offset:16128
  v_mfma_f32_16x16x32_bf16 v[28:31], v[48:51], v[148:151], v[28:31]
  ds_read_b64_tr_b16 v[64:65], v21 offset:15392
  ds_read_b64_tr_b16 v[66:67], v21 offset:16160
  v_mfma_f32_16x16x32_bf16 v[32:35], v[52:55], v[144:147], v[32:35]
  ds_read_b64_tr_b16 v[68:69], v21 offset:15424
  ds_read_b64_tr_b16 v[70:71], v21 offset:16192
  v_mfma_f32_16x16x32_bf16 v[36:39], v[52:55], v[148:151], v[36:39]
  v_mfma_f32_16x16x32_bf16 v[40:43], v[56:59], v[144:147], v[40:43]
  v_mfma_f32_16x16x32_bf16 v[44:47], v[56:59], v[148:151], v[44:47]
  s_add_u32 s55, s55, 18432
  s_cmp_eq_u32 s55, 110592
  s_cselect_b32 s55, 0, s55
  s_waitcnt vmcnt(24) lgkmcnt(0)
  s_barrier
  v_add_u32 v21, s55, v20
  v_mfma_f32_16x16x32_bf16 v[24:27], v[60:63], v[152:155], v[24:27]
  ds_read_b64_tr_b16 v[48:49], v21 offset:0
  ds_read_b64_tr_b16 v[50:51], v21 offset:768
  v_mfma_f32_16x16x32_bf16 v[28:31], v[60:63], v[156:159], v[28:31]
  ds_read_b64_tr_b16 v[52:53], v21 offset:32
  ds_read_b64_tr_b16 v[54:55], v21 offset:800
  v_mfma_f32_16x16x32_bf16 v[32:35], v[64:67], v[152:155], v[32:35]
  ds_read_b64_tr_b16 v[56:57], v21 offset:64
  ds_read_b64_tr_b16 v[58:59], v21 offset:832
  v_mfma_f32_16x16x32_bf16 v[36:39], v[64:67], v[156:159], v[36:39]
  v_mfma_f32_16x16x32_bf16 v[40:43], v[68:71], v[152:155], v[40:43]
  v_mfma_f32_16x16x32_bf16 v[44:47], v[68:71], v[156:159], v[44:47]
  s_waitcnt vmcnt(22) lgkmcnt(0)
  v_mfma_f32_16x16x32_bf16 v[24:27], v[48:51], v[160:163], v[24:27]
  ds_read_b64_tr_b16 v[60:61], v21 offset:3072
  ds_read_b64_tr_b16 v[62:63], v21 offset:3840
  v_mfma_f32_16x16x32_bf16 v[28:31], v[48:51], v[164:167], v[28:31]
  ds_read_b64_tr_b16 v[64:65], v21 offset:3104
  ds_read_b64_tr_b16 v[66:67], v21 offset:3872
  v_mfma_f32_16x16x32_bf16 v[32:35], v[52:55], v[160:163], v[32:35]
  ds_read_b64_tr_b16 v[68:69], v21 offset:3136
  ds_read_b64_tr_b16 v[70:71], v21 offset:3904
  v_mfma_f32_16x16x32_bf16 v[36:39], v[52:55], v[164:167], v[36:39]
  v_mfma_f32_16x16x32_bf16 v[40:43], v[56:59], v[160:163], v[40:43]
  v_mfma_f32_16x16x32_bf16 v[44:47], v[56:59], v[164:167], v[44:47]
  s_waitcnt vmcnt(20) lgkmcnt(0)
  v_mfma_f32_16x16x32_bf16 v[24:27], v[60:63], v[168:171], v[24:27]
  ds_read_b64_tr_b16 v[48:49], v21 offset:6144
  ds_read_b64_tr_b16 v[50:51], v21 offset:6912
  v_mfma_f32_16x16x32_bf16 v[28:31], v[60:63], v[172:175], v[28:31]
  ds_read_b64_tr_b16 v[52:53], v21 offset:6176
  ds_read_b64_tr_b16 v[54:55], v21 offset:6944
  v_mfma_f32_16x16x32_bf16 v[32:35], v[64:67], v[168:171], v[32:35]
  ds_read_b64_tr_b16 v[56:57], v21 offset:6208
  ds_read_b64_tr_b16 v[58:59], v21 offset:6976
  v_mfma_f32_16x16x32_bf16 v[36:39], v[64:67], v[172:175], v[36:39]
  v_mfma_f32_16x16x32_bf16 v[40:43], v[68:71], v[168:171], v[40:43]
  v_mfma_f32_16x16x32_bf16 v[44:47], v[68:71], v[172:175], v[44:47]
  s_waitcnt vmcnt(18) lgkmcnt(0)
  v_mfma_f32_16x16x32_bf16 v[24:27], v[48:51], v[176:179], v[24:27]
  ds_read_b64_tr_b16 v[60:61], v21 offset:9216
  ds_read_b64_tr_b16 v[62:63], v21 offset:9984
  v_mfma_f32_16x16x32_bf16 v[28:31], v[48:51], v[180:183], v[28:31]
  ds_read_b64_tr_b16 v[64:65], v21 offset:9248
  ds_read_b64_tr_b16 v[66:67], v21 offset:10016
  v_mfma_f32_16x16x32_bf16 v[32:35], v[52:55], v[176:179], v[32:35]
  ds_read_b64_tr_b16 v[68:69], v21 offset:9280
  ds_read_b64_tr_b16 v[70:71], v21 offset:10048
  v_mfma_f32_16x16x32_bf16 v[36:39], v[52:55], v[180:183], v[36:39]
  v_mfma_f32_16x16x32_bf16 v[40:43], v[56:59], v[176:179], v[40:43]
  v_mfma_f32_16x16x32_bf16 v[44:47], v[56:59], v[180:183], v[44:47]
  s_waitcnt vmcnt(16) lgkmcnt(0)
  v_mfma_f32_16x16x32_bf16 v[24:27], v[60:63], v[184:187], v[24:27]
  ds_read_b64_tr_b16 v[48:49], v21 offset:12288
  ds_read_b64_tr_b16 v[50:51], v21 offset:13056
  v_mfma_f32_16x16x32_bf16 v[28:31], v[60:63], v[188:191], v[28:31]
  ds_read_b64_tr_b16 v[52:53], v21 offset:12320
  ds_read_b64_tr_b16 v[54:55], v21 offset:13088
  v_mfma_f32_16x16x32_bf16 v[32:35], v[64:67], v[184:187], v[32:35]
  ds_read_b64_tr_b16 v[56:57], v21 offset:12352
  ds_read_b64_tr_b16 v[58:59], v21 offset:13120
  v_mfma_f32_16x16x32_bf16 v[36:39], v[64:67], v[188:191], v[36:39]
  v_mfma_f32_16x16x32_bf16 v[40:43], v[68:71], v[184:187], v[40:43]
  v_mfma_f32_16x16x32_bf16 v[44:47], v[68:71], v[188:191], v[44:47]
  s_waitcnt vmcnt(14) lgkmcnt(0)
  v_mfma_f32_16x16x32_bf16 v[24:27], v[48:51], v[192:195], v[24:27]
  ds_read_b64_tr_b16 v[60:61], v21 offset:15360
  ds_read_b64_tr_b16 v[62:63], v21 offset:16128
  v_mfma_f32_16x16x32_bf16 v[28:31], v[48:51], v[196:199], v[28:31]
  ds_read_b64_tr_b16 v[64:65], v21 offset:15392
  ds_read_b64_tr_b16 v[66:67], v21 offset:16160
  v_mfma_f32_16x16x32_bf16 v[32:35], v[52:55], v[192:195], v[32:35]
  ds_read_b64_tr_b16 v[68:69], v21 offset:15424
  ds_read_b64_tr_b16 v[70:71], v21 offset:16192
  v_mfma_f32_16x16x32_bf16 v[36:39], v[52:55], v[196:199], v[36:39]
  v_mfma_f32_16x16x32_bf16 v[40:43], v[56:59], v[192:195], v[40:43]
  v_mfma_f32_16x16x32_bf16 v[44:47], v[56:59], v[196:199], v[44:47]
  s_add_u32 s55, s55, 18432
  s_cmp_eq_u32 s55, 110592
  s_cselect_b32 s55, 0, s55
  s_waitcnt vmcnt(12) lgkmcnt(0)
  s_barrier
  v_add_u32 v21, s55, v20
  v_mfma_f32_16x16x32_bf16 v[24:27], v[60:63], v[200:203], v[24:27]
  ds_read_b64_tr_b16 v[48:49], v21 offset:0
  ds_read_b64_tr_b16 v[50:51], v21 offset:768
  v_mfma_f32_16x16x32_bf16 v[28:31], v[60:63], v[204:207], v[28:31]
  ds_read_b64_tr_b16 v[52:53], v21 offset:32
  ds_read_b64_tr_b16 v[54:55], v21 offset:800
  v_mfma_f32_16x16x32_bf16 v[32:35], v[64:67], v[200:203], v[32:35]
  ds_read_b64_tr_b16 v[56:57], v21 offset:64
  ds_read_b64_tr_b16 v[58:59], v21 offset:832
  v_mfma_f32_16x16x32_bf16 v[36:39], v[64:67], v[204:207], v[36:39]
  v_mfma_f32_16x16x32_bf16 v[40:43], v[68:71], v[200:203], v[40:43]
  v_mfma_f32_16x16x32_bf16 v[44:47], v[68:71], v[204:207], v[44:47]
  s_waitcnt vmcnt(10) lgkmcnt(0)
  v_mfma_f32_16x16x32_bf16 v[24:27], v[48:51], v[208:211], v[24:27]
  ds_read_b64_tr_b16 v[60:61], v21 offset:3072
  ds_read_b64_tr_b16 v[62:63], v21 offset:3840
  v_mfma_f32_16x16x32_bf16 v[28:31], v[48:51], v[212:215], v[28:31]
  ds_read_b64_tr_b16 v[64:65], v21 offset:3104
  ds_read_b64_tr_b16 v[66:67], v21 offset:3872
  v_mfma_f32_16x16x32_bf16 v[32:35], v[52:55], v[208:211], v[32:35]
  ds_read_b64_tr_b16 v[68:69], v21 offset:3136
  ds_read_b64_tr_b16 v[70:71], v21 offset:3904
  v_mfma_f32_16x16x32_bf16 v[36:39], v[52:55], v[212:215], v[36:39]
  v_mfma_f32_16x16x32_bf16 v[40:43], v[56:59], v[208:211], v[40:43]
  v_mfma_f32_16x16x32_bf16 v[44:47], v[56:59], v[212:215], v[44:47]
  s_waitcnt vmcnt(8) lgkmcnt(0)
  v_mfma_f32_16x16x32_bf16 v[24:27], v[60:63], v[216:219], v[24:27]
  ds_read_b64_tr_b16 v[48:49], v21 offset:6144
  ds_read_b64_tr_b16 v[50:51], v21 offset:6912
  v_mfma_f32_16x16x32_bf16 v[28:31], v[60:63], v[220:223], v[28:31]
  ds_read_b64_tr_b16 v[52:53], v21 offset:6176
  ds_read_b64_tr_b16 v[54:55], v21 offset:6944
  v_mfma_f32_16x16x32_bf16 v[32:35], v[64:67], v[216:219], v[32:35]
  ds_read_b64_tr_b16 v[56:57], v21 offset:6208
  ds_read_b64_tr_b16 v[58:59], v21 offset:6976
  v_mfma_f32_16x16x32_bf16 v[36:39], v[64:67], v[220:223], v[36:39]
  v_mfma_f32_16x16x32_bf16 v[40:43], v[68:71], v[216:219], v[40:43]
  v_mfma_f32_16x16x32_bf16 v[44:47], v[68:71], v[220:223], v[44:47]
  s_waitcnt vmcnt(6) lgkmcnt(0)
  v_mfma_f32_16x16x32_bf16 v[24:27], v[48:51], v[224:227], v[24:27]
  ds_read_b64_tr_b16 v[60:61], v21 offset:9216
  ds_read_b64_tr_b16 v[62:63], v21 offset:9984
  v_mfma_f32_16x16x32_bf16 v[28:31], v[48:51], v[228:231], v[28:31]
  ds_read_b64_tr_b16 v[64:65], v21 offset:9248
  ds_read_b64_tr_b16 v[66:67], v21 offset:10016
  v_mfma_f32_16x16x32_bf16 v[32:35], v[52:55], v[224:227], v[32:35]
  ds_read_b64_tr_b16 v[68:69], v21 offset:9280
  ds_read_b64_tr_b16 v[70:71], v21 offset:10048
  v_mfma_f32_16x16x32_bf16 v[36:39], v[52:55], v[228:231], v[36:39]
  v_mfma_f32_16x16x32_bf16 v[40:43], v[56:59], v[224:227], v[40:43]
  v_mfma_f32_16x16x32_bf16 v[44:47], v[56:59], v[228:231], v[44:47]
  s_waitcnt vmcnt(4) lgkmcnt(0)
  v_mfma_f32_16x16x32_bf16 v[24:27], v[60:63], v[232:235], v[24:27]
  ds_read_b64_tr_b16 v[48:49], v21 offset:12288
  ds_read_b64_tr_b16 v[50:51], v21 offset:13056
  v_mfma_f32_16x16x32_bf16 v[28:31], v[60:63], v[236:239], v[28:31]
  ds_read_b64_tr_b16 v[52:53], v21 offset:12320
  ds_read_b64_tr_b16 v[54:55], v21 offset:13088
  v_mfma_f32_16x16x32_bf16 v[32:35], v[64:67], v[232:235], v[32:35]
  ds_read_b64_tr_b16 v[56:57], v21 offset:12352
  ds_read_b64_tr_b16 v[58:59], v21 offset:13120
  v_mfma_f32_16x16x32_bf16 v[36:39], v[64:67], v[236:239], v[36:39]
  v_mfma_f32_16x16x32_bf16 v[40:43], v[68:71], v[232:235], v[40:43]
  v_mfma_f32_16x16x32_bf16 v[44:47], v[68:71], v[236:239], v[44:47]
  s_waitcnt vmcnt(2) lgkmcnt(0)
  v_mfma_f32_16x16x32_bf16 v[24:27], v[48:51], v[240:243], v[24:27]
  ds_read_b64_tr_b16 v[60:61], v21 offset:15360
  ds_read_b64_tr_b16 v[62:63], v21 offset:16128
  v_mfma_f32_16x16x32_bf16 v[28:31], v[48:51], v[244:247], v[28:31]
  ds_read_b64_tr_b16 v[64:65], v21 offset:15392
  ds_read_b64_tr_b16 v[66:67], v21 offset:16160
  v_mfma_f32_16x16x32_bf16 v[32:35], v[52:55], v[240:243], v[32:35]
  ds_read_b64_tr_b16 v[68:69], v21 offset:15424
  ds_read_b64_tr_b16 v[70:71], v21 offset:16192
  v_mfma_f32_16x16x32_bf16 v[36:39], v[52:55], v[244:247], v[36:39]
  v_mfma_f32_16x16x32_bf16 v[40:43], v[56:59], v[240:243], v[40:43]
  v_mfma_f32_16x16x32_bf16 v[44:47], v[56:59], v[244:247], v[44:47]
  s_add_u32 s55, s55, 18432
  s_cmp_eq_u32 s55, 110592
  s_cselect_b32 s55, 0, s55
  s_waitcnt vmcnt(0) lgkmcnt(0)
  s_barrier
  v_add_u32 v21, s55, v20
  v_mfma_f32_16x16x32_bf16 v[24:27], v[60:63], v[248:251], v[24:27]
  ds_read_b64_tr_b16 v[48:49], v21 offset:0
  ds_read_b64_tr_b16 v[50:51], v21 offset:768
  v_mfma_f32_16x16x32_bf16 v[28:31], v[60:63], v[252:255], v[28:31]
  ds_read_b64_tr_b16 v[52:53], v21 offset:32
  ds_read_b64_tr_b16 v[54:55], v21 offset:800
  v_mfma_f32_16x16x32_bf16 v[32:35], v[64:67], v[248:251], v[32:35]
  ds_read_b64_tr_b16 v[56:57], v21 offset:64
  ds_read_b64_tr_b16 v[58:59], v21 offset:832
  v_mfma_f32_16x16x32_bf16 v[36:39], v[64:67], v[252:255], v[36:39]
  v_mfma_f32_16x16x32_bf16 v[40:43], v[68:71], v[248:251], v[40:43]
  v_mfma_f32_16x16x32_bf16 v[44:47], v[68:71], v[252:255], v[44:47]
  s_add_u32 s63, s60, 65536
  s_add_u32 s64, s60, 131072
  s_cmp_eq_u32 s62, 2
  s_cselect_b32 s64, s61, s64
  s_cselect_b64 vcc, -1, 0
  v_add_u32 v81, 256, v80
  v_add_u32 v83, 128, v82
  v_cndmask_b32 v78, v80, v82, vcc
  v_cndmask_b32 v79, v81, v83, vcc
  v_pk_mul_f32 v[24:25], v[24:25], v[76:77]
  v_pk_mul_f32 v[26:27], v[26:27], v[76:77]
  v_cvt_pk_bf16_f32 v90, v24, v25
  v_cvt_pk_bf16_f32 v91, v26, v27
  buffer_store_dwordx2 v[90:91], v80, s[28:31], s60 offen offset:0 sc1
  v_pk_mul_f32 v[28:29], v[28:29], v[76:77]
  v_pk_mul_f32 v[30:31], v[30:31], v[76:77]
  v_cvt_pk_bf16_f32 v92, v28, v29
  v_cvt_pk_bf16_f32 v93, v30, v31
  buffer_store_dwordx2 v[92:93], v80, s[28:31], s60 offen offset:256 sc1
  v_pk_mul_f32 v[32:33], v[32:33], v[76:77]
  v_pk_mul_f32 v[34:35], v[34:35], v[76:77]
  v_cvt_pk_bf16_f32 v94, v32, v33
  v_cvt_pk_bf16_f32 v95, v34, v35
  buffer_store_dwordx2 v[94:95], v80, s[28:31], s63 offen offset:0 sc1
  v_pk_mul_f32 v[36:37], v[36:37], v[76:77]
  v_pk_mul_f32 v[38:39], v[38:39], v[76:77]
  v_cvt_pk_bf16_f32 v96, v36, v37
  v_cvt_pk_bf16_f32 v97, v38, v39
  buffer_store_dwordx2 v[96:97], v80, s[28:31], s63 offen offset:256 sc1
  v_pk_mul_f32 v[40:41], v[40:41], v[76:77]
  v_pk_mul_f32 v[42:43], v[42:43], v[76:77]
  v_cvt_pk_bf16_f32 v98, v40, v41
  v_cvt_pk_bf16_f32 v99, v42, v43
  buffer_store_dwordx2 v[98:99], v78, s[28:31], s64 offen sc1
  v_pk_mul_f32 v[44:45], v[44:45], v[76:77]
  v_pk_mul_f32 v[46:47], v[46:47], v[76:77]
  v_cvt_pk_bf16_f32 v100, v44, v45
  v_cvt_pk_bf16_f32 v101, v46, v47
  buffer_store_dwordx2 v[100:101], v79, s[28:31], s64 offen sc1
  s_add_u32 s60, s60, 196608
  s_add_u32 s62, s62, 1
  s_add_u32 s57, s57, 1
  s_cmp_lt_u32 s62, 3
  s_cbranch_scc1 L1_qk
  s_lshl_b32 s60, s38, 19
  s_add_u32 s60, s60, 2097152
  s_mov_b32 s61, 4456448
  s_mov_b32 s62, 0
  v_mov_b32 v80, v84
  v_mov_b32 v82, v86
  v_mov_b32 v76, 1.0
  v_mov_b32 v77, 1.0
  s_cmp_lt_u32 s57, 6
  s_cbranch_scc1 L1_qk
  s_mul_i32 s61, s38, 589824
  s_add_u32 s61, s61, 4718592
  s_mov_b32 s60, s61
L1_v:
  s_waitcnt vmcnt(34) lgkmcnt(0)
  v_mfma_f32_16x16x32_bf16 v[24:27], v[112:115], v[48:51], 0
  ds_read_b64_tr_b16 v[60:61], v21 offset:3072
  ds_read_b64_tr_b16 v[62:63], v21 offset:3840
  v_mfma_f32_16x16x32_bf16 v[28:31], v[116:119], v[48:51], 0
  ds_read_b64_tr_b16 v[64:65], v21 offset:3104
  ds_read_b64_tr_b16 v[66:67], v21 offset:3872
  v_mfma_f32_16x16x32_bf16 v[32:35], v[112:115], v[52:55], 0
  ds_read_b64_tr_b16 v[68:69], v21 offset:3136
  ds_read_b64_tr_b16 v[70:71], v21 offset:3904
  v_mfma_f32_16x16x32_bf16 v[36:39], v[116:119], v[52:55], 0
  v_mfma_f32_16x16x32_bf16 v[40:43], v[112:115], v[56:59], 0
  v_mfma_f32_16x16x32_bf16 v[44:47], v[116:119], v[56:59], 0
  s_waitcnt vmcnt(32) lgkmcnt(0)
  v_mfma_f32_16x16x32_bf16 v[24:27], v[120:123], v[60:63], v[24:27]
  ds_read_b64_tr_b16 v[48:49], v21 offset:6144
  ds_read_b64_tr_b16 v[50:51], v21 offset:6912
  v_mfma_f32_16x16x32_bf16 v[28:31], v[124:127], v[60:63], v[28:31]
  ds_read_b64_tr_b16 v[52:53], v21 offset:6176
  ds_read_b64_tr_b16 v[54:55], v21 offset:6944
  v_mfma_f32_16x16x32_bf16 v[32:35], v[120:123], v[64:67], v[32:35]
  ds_read_b64_tr_b16 v[56:57], v21 offset:6208
  ds_read_b64_tr_b16 v[58:59], v21 offset:6976
  v_mfma_f32_16x16x32_bf16 v[36:39], v[124:127], v[64:67], v[36:39]
  v_mfma_f32_16x16x32_bf16 v[40:43], v[120:123], v[68:71], v[40:43]
  v_mfma_f32_16x16x32_bf16 v[44:47], v[124:127], v[68:71], v[44:47]
  s_waitcnt vmcnt(30) lgkmcnt(0)
  v_mfma_f32_16x16x32_bf16 v[24:27], v[128:131], v[48:51], v[24:27]
  ds_read_b64_tr_b16 v[60:61], v21 offset:9216
  ds_read_b64_tr_b16 v[62:63], v21 offset:9984
  v_mfma_f32_16x16x32_bf16 v[28:31], v[132:135], v[48:51], v[28:31]
  ds_read_b64_tr_b16 v[64:65], v21 offset:9248
  ds_read_b64_tr_b16 v[66:67], v21 offset:10016
  v_mfma_f32_16x16x32_bf16 v[32:35], v[128:131], v[52:55], v[32:35]
  ds_read_b64_tr_b16 v[68:69], v21 offset:9280
  ds_read_b64_tr_b16 v[70:71], v21 offset:10048
  v_mfma_f32_16x16x32_bf16 v[36:39], v[132:135], v[52:55], v[36:39]
  v_mfma_f32_16x16x32_bf16 v[40:43], v[128:131], v[56:59], v[40:43]
  v_mfma_f32_16x16x32_bf16 v[44:47], v[132:135], v[56:59], v[44:47]
  s_waitcnt vmcnt(28) lgkmcnt(0)
  v_mfma_f32_16x16x32_bf16 v[24:27], v[136:139], v[60:63], v[24:27]
  ds_read_b64_tr_b16 v[48:49], v21 offset:12288
  ds_read_b64_tr_b16 v[50:51], v21 offset:13056
  v_mfma_f32_16x16x32_bf16 v[28:31], v[140:143], v[60:63], v[28:31]
  ds_read_b64_tr_b16 v[52:53], v21 offset:12320
  ds_read_b64_tr_b16 v[54:55], v21 offset:13088
  v_mfma_f32_16x16x32_bf16 v[32:35], v[136:139], v[64:67], v[32:35]
  ds_read_b64_tr_b16 v[56:57], v21 offset:12352
  ds_read_b64_tr_b16 v[58:59], v21 offset:13120
  v_mfma_f32_16x16x32_bf16 v[36:39], v[140:143], v[64:67], v[36:39]
  v_mfma_f32_16x16x32_bf16 v[40:43], v[136:139], v[68:71], v[40:43]
  v_mfma_f32_16x16x32_bf16 v[44:47], v[140:143], v[68:71], v[44:47]
  s_waitcnt vmcnt(26) lgkmcnt(0)
  v_mfma_f32_16x16x32_bf16 v[24:27], v[144:147], v[48:51], v[24:27]
  ds_read_b64_tr_b16 v[60:61], v21 offset:15360
  ds_read_b64_tr_b16 v[62:63], v21 offset:16128
  v_mfma_f32_16x16x32_bf16 v[28:31], v[148:151], v[48:51], v[28:31]
  ds_read_b64_tr_b16 v[64:65], v21 offset:15392
  ds_read_b64_tr_b16 v[66:67], v21 offset:16160
  v_mfma_f32_16x16x32_bf16 v[32:35], v[144:147], v[52:55], v[32:35]
  ds_read_b64_tr_b16 v[68:69], v21 offset:15424
  ds_read_b64_tr_b16 v[70:71], v21 offset:16192
  v_mfma_f32_16x16x32_bf16 v[36:39], v[148:151], v[52:55], v[36:39]
  v_mfma_f32_16x16x32_bf16 v[40:43], v[144:147], v[56:59], v[40:43]
  v_mfma_f32_16x16x32_bf16 v[44:47], v[148:151], v[56:59], v[44:47]
  s_add_u32 s55, s55, 18432
  s_cmp_eq_u32 s55, 110592
  s_cselect_b32 s55, 0, s55
  s_waitcnt vmcnt(24) lgkmcnt(0)
  s_barrier
  v_add_u32 v21, s55, v20
  v_mfma_f32_16x16x32_bf16 v[24:27], v[152:155], v[60:63], v[24:27]
  ds_read_b64_tr_b16 v[48:49], v21 offset:0
  ds_read_b64_tr_b16 v[50:51], v21 offset:768
  v_mfma_f32_16x16x32_bf16 v[28:31], v[156:159], v[60:63], v[28:31]
  ds_read_b64_tr_b16 v[52:53], v21 offset:32
  ds_read_b64_tr_b16 v[54:55], v21 offset:800
  v_mfma_f32_16x16x32_bf16 v[32:35], v[152:155], v[64:67], v[32:35]
  ds_read_b64_tr_b16 v[56:57], v21 offset:64
  ds_read_b64_tr_b16 v[58:59], v21 offset:832
  v_mfma_f32_16x16x32_bf16 v[36:39], v[156:159], v[64:67], v[36:39]
  v_mfma_f32_16x16x32_bf16 v[40:43], v[152:155], v[68:71], v[40:43]
  v_mfma_f32_16x16x32_bf16 v[44:47], v[156:159], v[68:71], v[44:47]
  s_waitcnt vmcnt(22) lgkmcnt(0)
  v_mfma_f32_16x16x32_bf16 v[24:27], v[160:163], v[48:51], v[24:27]
  ds_read_b64_tr_b16 v[60:61], v21 offset:3072
  ds_read_b64_tr_b16 v[62:63], v21 offset:3840
  v_mfma_f32_16x16x32_bf16 v[28:31], v[164:167], v[48:51], v[28:31]
  ds_read_b64_tr_b16 v[64:65], v21 offset:3104
  ds_read_b64_tr_b16 v[66:67], v21 offset:3872
  v_mfma_f32_16x16x32_bf16 v[32:35], v[160:163], v[52:55], v[32:35]
  ds_read_b64_tr_b16 v[68:69], v21 offset:3136
  ds_read_b64_tr_b16 v[70:71], v21 offset:3904
  v_mfma_f32_16x16x32_bf16 v[36:39], v[164:167], v[52:55], v[36:39]
  v_mfma_f32_16x16x32_bf16 v[40:43], v[160:163], v[56:59], v[40:43]
  v_mfma_f32_16x16x32_bf16 v[44:47], v[164:167], v[56:59], v[44:47]
  s_waitcnt vmcnt(20) lgkmcnt(0)
  v_mfma_f32_16x16x32_bf16 v[24:27], v[168:171], v[60:63], v[24:27]
  ds_read_b64_tr_b16 v[48:49], v21 offset:6144
  ds_read_b64_tr_b16 v[50:51], v21 offset:6912
  v_mfma_f32_16x16x32_bf16 v[28:31], v[172:175], v[60:63], v[28:31]
  ds_read_b64_tr_b16 v[52:53], v21 offset:6176
  ds_read_b64_tr_b16 v[54:55], v21 offset:6944
  v_mfma_f32_16x16x32_bf16 v[32:35], v[168:171], v[64:67], v[32:35]
  ds_read_b64_tr_b16 v[56:57], v21 offset:6208
  ds_read_b64_tr_b16 v[58:59], v21 offset:6976
  v_mfma_f32_16x16x32_bf16 v[36:39], v[172:175], v[64:67], v[36:39]
  v_mfma_f32_16x16x32_bf16 v[40:43], v[168:171], v[68:71], v[40:43]
  v_mfma_f32_16x16x32_bf16 v[44:47], v[172:175], v[68:71], v[44:47]
  s_waitcnt vmcnt(18) lgkmcnt(0)
  v_mfma_f32_16x16x32_bf16 v[24:27], v[176:179], v[48:51], v[24:27]
  ds_read_b64_tr_b16 v[60:61], v21 offset:9216
  ds_read_b64_tr_b16 v[62:63], v21 offset:9984
  v_mfma_f32_16x16x32_bf16 v[28:31], v[180:183], v[48:51], v[28:31]
  ds_read_b64_tr_b16 v[64:65], v21 offset:9248
  ds_read_b64_tr_b16 v[66:67], v21 offset:10016
  v_mfma_f32_16x16x32_bf16 v[32:35], v[176:179], v[52:55], v[32:35]
  ds_read_b64_tr_b16 v[68:69], v21 offset:9280
  ds_read_b64_tr_b16 v[70:71], v21 offset:10048
  v_mfma_f32_16x16x32_bf16 v[36:39], v[180:183], v[52:55], v[36:39]
  v_mfma_f32_16x16x32_bf16 v[40:43], v[176:179], v[56:59], v[40:43]
  v_mfma_f32_16x16x32_bf16 v[44:47], v[180:183], v[56:59], v[44:47]
  s_waitcnt vmcnt(16) lgkmcnt(0)
  v_mfma_f32_16x16x32_bf16 v[24:27], v[184:187], v[60:63], v[24:27]
  ds_read_b64_tr_b16 v[48:49], v21 offset:12288
  ds_read_b64_tr_b16 v[50:51], v21 offset:13056
  v_mfma_f32_16x16x32_bf16 v[28:31], v[188:191], v[60:63], v[28:31]
  ds_read_b64_tr_b16 v[52:53], v21 offset:12320
  ds_read_b64_tr_b16 v[54:55], v21 offset:13088
  v_mfma_f32_16x16x32_bf16 v[32:35], v[184:187], v[64:67], v[32:35]
  ds_read_b64_tr_b16 v[56:57], v21 offset:12352
  ds_read_b64_tr_b16 v[58:59], v21 offset:13120
  v_mfma_f32_16x16x32_bf16 v[36:39], v[188:191], v[64:67], v[36:39]
  v_mfma_f32_16x16x32_bf16 v[40:43], v[184:187], v[68:71], v[40:43]
  v_mfma_f32_16x16x32_bf16 v[44:47], v[188:191], v[68:71], v[44:47]
  s_waitcnt vmcnt(14) lgkmcnt(0)
  v_mfma_f32_16x16x32_bf16 v[24:27], v[192:195], v[48:51], v[24:27]
  ds_read_b64_tr_b16 v[60:61], v21 offset:15360
  ds_read_b64_tr_b16 v[62:63], v21 offset:16128
  v_mfma_f32_16x16x32_bf16 v[28:31], v[196:199], v[48:51], v[28:31]
  ds_read_b64_tr_b16 v[64:65], v21 offset:15392
  ds_read_b64_tr_b16 v[66:67], v21 offset:16160
  v_mfma_f32_16x16x32_bf16 v[32:35], v[192:195], v[52:55], v[32:35]
  ds_read_b64_tr_b16 v[68:69], v21 offset:15424
  ds_read_b64_tr_b16 v[70:71], v21 offset:16192
  v_mfma_f32_16x16x32_bf16 v[36:39], v[196:199], v[52:55], v[36:39]
  v_mfma_f32_16x16x32_bf16 v[40:43], v[192:195], v[56:59], v[40:43]
  v_mfma_f32_16x16x32_bf16 v[44:47], v[196:199], v[56:59], v[44:47]
  s_add_u32 s55, s55, 18432
  s_cmp_eq_u32 s55, 110592
  s_cselect_b32 s55, 0, s55
  s_waitcnt vmcnt(12) lgkmcnt(0)
  s_barrier
  v_add_u32 v21, s55, v20
  v_mfma_f32_16x16x32_bf16 v[24:27], v[200:203], v[60:63], v[24:27]
  ds_read_b64_tr_b16 v[48:49], v21 offset:0
  ds_read_b64_tr_b16 v[50:51], v21 offset:768
  v_mfma_f32_16x16x32_bf16 v[28:31], v[204:207], v[60:63], v[28:31]
  ds_read_b64_tr_b16 v[52:53], v21 offset:32
  ds_read_b64_tr_b16 v[54:55], v21 offset:800
  v_mfma_f32_16x16x32_bf16 v[32:35], v[200:203], v[64:67], v[32:35]
  ds_read_b64_tr_b16 v[56:57], v21 offset:64
  ds_read_b64_tr_b16 v[58:59], v21 offset:832
  v_mfma_f32_16x16x32_bf16 v[36:39], v[204:207], v[64:67], v[36:39]
  v_mfma_f32_16x16x32_bf16 v[40:43], v[200:203], v[68:71], v[40:43]
  v_mfma_f32_16x16x32_bf16 v[44:47], v[204:207], v[68:71], v[44:47]
  s_waitcnt vmcnt(10) lgkmcnt(0)
  v_mfma_f32_16x16x32_bf16 v[24:27], v[208:211], v[48:51], v[24:27]
  ds_read_b64_tr_b16 v[60:61], v21 offset:3072
  ds_read_b64_tr_b16 v[62:63], v21 offset:3840
  v_mfma_f32_16x16x32_bf16 v[28:31], v[212:215], v[48:51], v[28:31]
  ds_read_b64_tr_b16 v[64:65], v21 offset:3104
  ds_read_b64_tr_b16 v[66:67], v21 offset:3872
  v_mfma_f32_16x16x32_bf16 v[32:35], v[208:211], v[52:55], v[32:35]
  ds_read_b64_tr_b16 v[68:69], v21 offset:3136
  ds_read_b64_tr_b16 v[70:71], v21 offset:3904
  v_mfma_f32_16x16x32_bf16 v[36:39], v[212:215], v[52:55], v[36:39]
  v_mfma_f32_16x16x32_bf16 v[40:43], v[208:211], v[56:59], v[40:43]
  v_mfma_f32_16x16x32_bf16 v[44:47], v[212:215], v[56:59], v[44:47]
  s_waitcnt vmcnt(8) lgkmcnt(0)
  v_mfma_f32_16x16x32_bf16 v[24:27], v[216:219], v[60:63], v[24:27]
  ds_read_b64_tr_b16 v[48:49], v21 offset:6144
  ds_read_b64_tr_b16 v[50:51], v21 offset:6912
  v_mfma_f32_16x16x32_bf16 v[28:31], v[220:223], v[60:63], v[28:31]
  ds_read_b64_tr_b16 v[52:53], v21 offset:6176
  ds_read_b64_tr_b16 v[54:55], v21 offset:6944
  v_mfma_f32_16x16x32_bf16 v[32:35], v[216:219], v[64:67], v[32:35]
  ds_read_b64_tr_b16 v[56:57], v21 offset:6208
  ds_read_b64_tr_b16 v[58:59], v21 offset:6976
  v_mfma_f32_16x16x32_bf16 v[36:39], v[220:223], v[64:67], v[36:39]
  v_mfma_f32_16x16x32_bf16 v[40:43], v[216:219], v[68:71], v[40:43]
  v_mfma_f32_16x16x32_bf16 v[44:47], v[220:223], v[68:71], v[44:47]
  s_waitcnt vmcnt(6) lgkmcnt(0)
  v_mfma_f32_16x16x32_bf16 v[24:27], v[224:227], v[48:51], v[24:27]
  ds_read_b64_tr_b16 v[60:61], v21 offset:9216
  ds_read_b64_tr_b16 v[62:63], v21 offset:9984
  v_mfma_f32_16x16x32_bf16 v[28:31], v[228:231], v[48:51], v[28:31]
  ds_read_b64_tr_b16 v[64:65], v21 offset:9248
  ds_read_b64_tr_b16 v[66:67], v21 offset:10016
  v_mfma_f32_16x16x32_bf16 v[32:35], v[224:227], v[52:55], v[32:35]
  ds_read_b64_tr_b16 v[68:69], v21 offset:9280
  ds_read_b64_tr_b16 v[70:71], v21 offset:10048
  v_mfma_f32_16x16x32_bf16 v[36:39], v[228:231], v[52:55], v[36:39]
  v_mfma_f32_16x16x32_bf16 v[40:43], v[224:227], v[56:59], v[40:43]
  v_mfma_f32_16x16x32_bf16 v[44:47], v[228:231], v[56:59], v[44:47]
  s_waitcnt vmcnt(4) lgkmcnt(0)
  v_mfma_f32_16x16x32_bf16 v[24:27], v[232:235], v[60:63], v[24:27]
  ds_read_b64_tr_b16 v[48:49], v21 offset:12288
  ds_read_b64_tr_b16 v[50:51], v21 offset:13056
  v_mfma_f32_16x16x32_bf16 v[28:31], v[236:239], v[60:63], v[28:31]
  ds_read_b64_tr_b16 v[52:53], v21 offset:12320
  ds_read_b64_tr_b16 v[54:55], v21 offset:13088
  v_mfma_f32_16x16x32_bf16 v[32:35], v[232:235], v[64:67], v[32:35]
  ds_read_b64_tr_b16 v[56:57], v21 offset:12352
  ds_read_b64_tr_b16 v[58:59], v21 offset:13120
  v_mfma_f32_16x16x32_bf16 v[36:39], v[236:239], v[64:67], v[36:39]
  v_mfma_f32_16x16x32_bf16 v[40:43], v[232:235], v[68:71], v[40:43]
  v_mfma_f32_16x16x32_bf16 v[44:47], v[236:239], v[68:71], v[44:47]
  s_waitcnt vmcnt(2) lgkmcnt(0)
  v_mfma_f32_16x16x32_bf16 v[24:27], v[240:243], v[48:51], v[24:27]
  ds_read_b64_tr_b16 v[60:61], v21 offset:15360
  ds_read_b64_tr_b16 v[62:63], v21 offset:16128
  v_mfma_f32_16x16x32_bf16 v[28:31], v[244:247], v[48:51], v[28:31]
  ds_read_b64_tr_b16 v[64:65], v21 offset:15392
  ds_read_b64_tr_b16 v[66:67], v21 offset:16160
  v_mfma_f32_16x16x32_bf16 v[32:35], v[240:243], v[52:55], v[32:35]
  ds_read_b64_tr_b16 v[68:69], v21 offset:15424
  ds_read_b64_tr_b16 v[70:71], v21 offset:16192
  v_mfma_f32_16x16x32_bf16 v[36:39], v[244:247], v[52:55], v[36:39]
  v_mfma_f32_16x16x32_bf16 v[40:43], v[240:243], v[56:59], v[40:43]
  v_mfma_f32_16x16x32_bf16 v[44:47], v[244:247], v[56:59], v[44:47]
  s_add_u32 s55, s55, 18432
  s_cmp_eq_u32 s55, 110592
  s_cselect_b32 s55, 0, s55
  s_waitcnt vmcnt(0) lgkmcnt(0)
  s_barrier
  v_add_u32 v21, s55, v20
  v_mfma_f32_16x16x32_bf16 v[24:27], v[248:251], v[60:63], v[24:27]
  ds_read_b64_tr_b16 v[48:49], v21 offset:0
  ds_read_b64_tr_b16 v[50:51], v21 offset:768
  v_mfma_f32_16x16x32_bf16 v[28:31], v[252:255], v[60:63], v[28:31]
  ds_read_b64_tr_b16 v[52:53], v21 offset:32
  ds_read_b64_tr_b16 v[54:55], v21 offset:800
  v_mfma_f32_16x16x32_bf16 v[32:35], v[248:251], v[64:67], v[32:35]
  ds_read_b64_tr_b16 v[56:57], v21 offset:64
  ds_read_b64_tr_b16 v[58:59], v21 offset:832
  v_mfma_f32_16x16x32_bf16 v[36:39], v[252:255], v[64:67], v[36:39]
  v_mfma_f32_16x16x32_bf16 v[40:43], v[248:251], v[68:71], v[40:43]
  v_mfma_f32_16x16x32_bf16 v[44:47], v[252:255], v[68:71], v[44:47]
  s_add_u32 s63, s60, 73728
  s_add_u32 s64, s60, 147456
  s_cmp_eq_u32 s62, 2
  s_cselect_b32 s64, s61, s64
  s_cselect_b64 vcc, -1, 0
  s_nop 1
  v_cndmask_b32 v78, v88, v89, vcc
  s_nop 3
  v_cvt_pk_bf16_f32 v90, v24, v25
  v_cvt_pk_bf16_f32 v91, v26, v27
  buffer_store_dwordx2 v[90:91], v88, s[28:31], s60 offen offset:0 sc1
  v_cvt_pk_bf16_f32 v92, v28, v29
  v_cvt_pk_bf16_f32 v93, v30, v31
  buffer_store_dwordx2 v[92:93], v88, s[28:31], s60 offen offset:576 sc1
  v_cvt_pk_bf16_f32 v94, v32, v33
  v_cvt_pk_bf16_f32 v95, v34, v35
  buffer_store_dwordx2 v[94:95], v88, s[28:31], s63 offen offset:0 sc1
  v_cvt_pk_bf16_f32 v96, v36, v37
  v_cvt_pk_bf16_f32 v97, v38, v39
  buffer_store_dwordx2 v[96:97], v88, s[28:31], s63 offen offset:576 sc1
  v_cvt_pk_bf16_f32 v98, v40, v41
  v_cvt_pk_bf16_f32 v99, v42, v43
  buffer_store_dwordx2 v[98:99], v78, s[28:31], s64 offen offset:0 sc1
  v_cvt_pk_bf16_f32 v100, v44, v45
  v_cvt_pk_bf16_f32 v101, v46, v47
  buffer_store_dwordx2 v[100:101], v78, s[28:31], s64 offen offset:576 sc1
  s_add_u32 s60, s60, 221184
  s_add_u32 s62, s62, 1
  s_cmp_lt_u32 s62, 3
  s_cbranch_scc1 L1_v
L1_end:
  s_endpgm
  .globl k2_kernel
  .p2align 8
  .type k2_kernel,@function
k2_kernel:
  s_cmp_ge_u32 s2, 256
  s_cbranch_scc1 L2_end
  s_load_dwordx2 s[4:5], s[0:1], 48
  s_load_dwordx2 s[8:9], s[0:1], 80
  s_cmp_ge_u32 s2, 192
  s_cbranch_scc1 L2_attn
  s_and_b32 s36, s2, 7
  s_lshr_b32 s37, s2, 3
  s_mul_i32 s38, s37, 43
  s_lshr_b32 s38, s38, 7
  s_mul_i32 s39, s38, 3
  s_sub_u32 s39, s37, s39
  s_and_b32 s40, s36, 3
  s_lshr_b32 s36, s36, 2
  s_lshl_b32 s36, s36, 3
  s_add_u32 s38, s38, s36
  s_lshl_b32 s42, s38, 8
  v_lshrrev_b32 v2, 6, v0
  v_and_b32 v1, 63, v0
  v_readfirstlane_b32 s18, v2
  v_lshrrev_b32 v2, 4, v1
  v_and_b32 v3, 15, v1
  v_lshrrev_b32 v4, 2, v3
  v_and_b32 v5, 3, v3
  s_waitcnt lgkmcnt(0)
  s_cmp_lt_u32 s18, 4
  s_cbranch_scc1 L2_mc
  s_add_u32 s20, s8, 20971520
  s_addc_u32 s21, s9, 0
  s_mov_b32 s22, 5308416
  s_mov_b32 s23, 0x20000
  s_mov_b32 s24, s4
  s_mov_b32 s25, s5
  s_mov_b32 s26, 18874368
  s_mov_b32 s27, 0x20000
  s_sub_u32 s19, s18, 4
  s_mul_i32 s45, s19, 18432
  s_mul_i32 s46, s39, 6144
  s_add_u32 s45, s45, s46
  v_lshl_add_u32 v10, v1, 4, s45
  v_add_u32 v11, 4096, v10
  s_mul_i32 s47, s19, 6144
  s_lshl_b32 s45, s19, 8
  s_lshl_b32 s48, s19, 12
  s_add_u32 s48, s48, 24576
  v_add_u32 v6, s45, v1
  v_add_u32 v6, 0, v6
  v_lshrrev_b32 v7, 4, v6
  v_and_b32 v8, 15, v6
  v_and_b32 v9, 7, v7
  v_lshlrev_b32 v9, 1, v9
  v_xor_b32 v8, v8, v9
  v_lshlrev_b32 v7, 12, v7
  v_lshl_add_u32 v7, v8, 4, v7
  v_add_u32 v7, s42, v7
  v_subrev_u32 v16, 0, v7
  v_add_u32 v6, s45, v1
  v_add_u32 v6, 64, v6
  v_lshrrev_b32 v7, 4, v6
  v_and_b32 v8, 15, v6
  v_and_b32 v9, 7, v7
  v_lshlrev_b32 v9, 1, v9
  v_xor_b32 v8, v8, v9
  v_lshlrev_b32 v7, 12, v7
  v_lshl_add_u32 v7, v8, 4, v7
  v_add_u32 v7, s42, v7
  v_subrev_u32 v17, 1024, v7
  v_add_u32 v6, s45, v1
  v_add_u32 v6, 128, v6
  v_lshrrev_b32 v7, 4, v6
  v_and_b32 v8, 15, v6
  v_and_b32 v9, 7, v7
  v_lshlrev_b32 v9, 1, v9
  v_xor_b32 v8, v8, v9
  v_lshlrev_b32 v7, 12, v7
  v_lshl_add_u32 v7, v8, 4, v7
  v_add_u32 v7, s42, v7
  v_subrev_u32 v18, 2048, v7
  v_add_u32 v6, s45, v1
  v_add_u32 v6, 192, v6
  v_lshrrev_b32 v7, 4, v6
  v_and_b32 v8, 15, v6
  v_and_b32 v9, 7, v7
  v_lshlrev_b32 v9, 1, v9
  v_xor_b32 v8, v8, v9
  v_lshlrev_b32 v7, 12, v7
  v_lshl_add_u32 v7, v8, 4, v7
  v_add_u32 v7, s42, v7
  v_subrev_u32 v19, 3072, v7
  s_mul_i32 s60, s40, 1327104
  s_mul_i32 s61, s40, 4718592
  s_add_u32 s22, s60, 1327104
  s_add_u32 s26, s61, 4718592
  s_and_b32 s58, s38, 7
  s_mul_i32 s59, s39, 3
  s_add_u32 s58, s58, s59
  s_sub_u32 s59, s58, 9
  s_cmp_ge_u32 s58, 9
  s_cselect_b32 s58, s59, s58
  s_mov_b32 s59, 0
  s_and_b32 s58, s38, 7
  s_add_u32 s58, s58, s39
  s_mul_i32 s59, s58, 43
  s_lshr_b32 s59, s59, 7
  s_mul_i32 s59, s59, 3
  s_mov_b32 s67, s60
  s_mov_b32 s68, s61
  s_sub_u32 s61, s58, s59
  s_mov_b32 s59, 0
  s_mov_b32 s66, 0
  s_bfe_u32 s69, s2, 0x10002
  s_mul_i32 s69, s69, 9
  s_mov_b32 s65, 0
  s_mov_b32 s53, 0
  s_lshr_b32 s63, s66, 0
  s_mul_i32 s62, s63, 43
  s_lshr_b32 s62, s62, 7
  s_mul_i32 s62, s62, 3
  s_sub_u32 s62, s63, s62
  s_cmp_eq_u32 s62, s61
  s_cselect_b32 s62, 3, 0
  s_cselect_b32 s63, 1, 0
  s_cmp_ge_u32 s66, 15
  s_cselect_b32 s62, s63, s62
  s_cselect_b32 s63, s63, 0
  s_add_u32 s58, s66, s62
  s_add_u32 s63, s63, 1
  s_mul_i32 s62, s61, 1
  s_add_u32 s62, s62, s59
  s_cmp_lt_u32 s59, 1
  s_cselect_b32 s58, s62, s58
  s_cselect_b32 s63, 0, s63
  s_add_u32 s66, s66, s63
  s_add_u32 s59, s59, 1
  s_mul_i32 s52, s58, 73728
  s_add_u32 s52, s52, s67
  s_lshl_b32 s54, s58, 18
  s_add_u32 s54, s54, s68
  s_add_u32 s64, s53, s47
  s_add_u32 m0, s53, s48
  s_mov_b32 s57, 0
Lldg_15:
  buffer_load_dwordx4 v16, s[24:27], s54 offen offset:0 lds
  buffer_load_dwordx4 v17, s[24:27], s54 offen offset:1024 lds
  buffer_load_dwordx4 v18, s[24:27], s54 offen offset:2048 lds
  buffer_load_dwordx4 v19, s[24:27], s54 offen offset:3072 lds
  s_mov_b32 m0, s64
  s_nop 0
  buffer_load_dwordx4 v10, s[20:23], s52 offen offset:0 lds
  buffer_load_dwordx4 v10, s[20:23], s52 offen offset:1024 lds
  buffer_load_dwordx4 v10, s[20:23], s52 offen offset:2048 lds
  buffer_load_dwordx4 v10, s[20:23], s52 offen offset:3072 lds
  s_add_u32 m0, m0, 4096
  s_nop 0
  buffer_load_dwordx4 v11, s[20:23], s52 offen offset:0 lds
  buffer_load_dwordx4 v11, s[20:23], s52 offen offset:1024 lds
  s_add_u32 s53, s53, 40960
  s_cmp_eq_u32 s53, 122880
  s_cselect_b32 s53, 0, s53
  s_lshr_b32 s63, s66, 0
  s_mul_i32 s62, s63, 43
  s_lshr_b32 s62, s62, 7
  s_mul_i32 s62, s62, 3
  s_sub_u32 s62, s63, s62
  s_cmp_eq_u32 s62, s61
  s_cselect_b32 s62, 3, 0
  s_cselect_b32 s63, 1, 0
  s_cmp_ge_u32 s66, 15
  s_cselect_b32 s62, s63, s62
  s_cselect_b32 s63, s63, 0
  s_add_u32 s58, s66, s62
  s_add_u32 s63, s63, 1
  s_mul_i32 s62, s61, 1
  s_add_u32 s62, s62, s59
  s_cmp_lt_u32 s59, 1
  s_cselect_b32 s58, s62, s58
  s_cselect_b32 s63, 0, s63
  s_add_u32 s66, s66, s63
  s_add_u32 s59, s59, 1
  s_mul_i32 s52, s58, 73728
  s_add_u32 s52, s52, s67
  s_lshl_b32 s54, s58, 18
  s_add_u32 s54, s54, s68
  s_add_u32 s64, s53, s47
  s_add_u32 m0, s53, s48
  s_add_u32 s57, s57, 1
  s_cmp_lg_u32 s57, 2
  s_cbranch_scc1 Lldg_17
  s_waitcnt vmcnt(10)
  s_barrier
Lldg_17:
  s_cmp_lt_u32 s57, 3
  s_cbranch_scc1 Lldg_15
Lldg_16:
  s_waitcnt vmcnt(10)
  s_barrier
  buffer_load_dwordx4 v16, s[24:27], s54 offen offset:0 lds
  buffer_load_dwordx4 v17, s[24:27], s54 offen offset:1024 lds
  buffer_load_dwordx4 v18, s[24:27], s54 offen offset:2048 lds
  buffer_load_dwordx4 v19, s[24:27], s54 offen offset:3072 lds
  s_mov_b32 m0, s64
  s_nop 0
  buffer_load_dwordx4 v10, s[20:23], s52 offen offset:0 lds
  buffer_load_dwordx4 v10, s[20:23], s52 offen offset:1024 lds
  buffer_load_dwordx4 v10, s[20:23], s52 offen offset:2048 lds
  buffer_load_dwordx4 v10, s[20:23], s52 offen offset:3072 lds
  s_add_u32 m0, m0, 4096
  s_nop 0
  buffer_load_dwordx4 v11, s[20:23], s52 offen offset:0 lds
  buffer_load_dwordx4 v11, s[20:23], s52 offen offset:1024 lds
  s_add_u32 s53, s53, 40960
  s_cmp_eq_u32 s53, 122880
  s_cselect_b32 s53, 0, s53
  s_lshr_b32 s63, s66, 0
  s_mul_i32 s62, s63, 43
  s_lshr_b32 s62, s62, 7
  s_mul_i32 s62, s62, 3
  s_sub_u32 s62, s63, s62
  s_cmp_eq_u32 s62, s61
  s_cselect_b32 s62, 3, 0
  s_cselect_b32 s63, 1, 0
  s_cmp_ge_u32 s66, 15
  s_cselect_b32 s62, s63, s62
  s_cselect_b32 s63, s63, 0
  s_add_u32 s58, s66, s62
  s_add_u32 s63, s63, 1
  s_mul_i32 s62, s61, 1
  s_add_u32 s62, s62, s59
  s_cmp_lt_u32 s59, 1
  s_cselect_b32 s58, s62, s58
  s_cselect_b32 s63, 0, s63
  s_add_u32 s66, s66, s63
  s_add_u32 s59, s59, 1
  s_mul_i32 s52, s58, 73728
  s_add_u32 s52, s52, s67
  s_lshl_b32 s54, s58, 18
  s_add_u32 s54, s54, s68
  s_add_u32 s64, s53, s47
  s_add_u32 m0, s53, s48
  s_add_u32 s57, s57, 1
  s_cmp_lt_u32 s57, 18
  s_cbranch_scc1 Lldg_16
  s_waitcnt vmcnt(10)
  s_barrier
  s_waitcnt vmcnt(0)
  s_barrier
  s_waitcnt vmcnt(0)
  s_barrier
  s_endpgm
L2_mc:
  s_add_u32 s28, s8, 27262976
  s_addc_u32 s29, s9, 0
  s_mov_b32 s30, 9437184
  s_mov_b32 s31, 0x20000
  s_and_b32 s43, s18, 1
  s_lshr_b32 s44, s18, 1
  v_lshl_add_u32 v6, v2, 2, v4
  v_lshrrev_b32 v7, 1, v5
  v_lshlrev_b32 v7, 3, v7
  v_xor_b32 v7, v7, v6
  v_lshl_add_u32 v7, v5, 4, v7
  s_mul_i32 s55, s44, 3072
  v_lshl_add_u32 v20, v7, 3, s55
  v_lshlrev_b32 v7, 8, v6
  v_lshl_add_u32 v7, v5, 3, v7
  v_add_u32 v7, 24576, v7
  v_and_b32 v8, 7, v6
  s_lshl_b32 s55, s43, 2
  s_add_u32 s56, s55, 0
  v_xor_b32 v9, s56, v8
  v_lshl_add_u32 v21, v9, 5, v7
  s_add_u32 s56, s55, 1
  v_xor_b32 v9, s56, v8
  v_lshl_add_u32 v22, v9, 5, v7
  s_add_u32 s56, s55, 2
  v_xor_b32 v9, s56, v8
  v_lshl_add_u32 v23, v9, 5, v7
  s_add_u32 s56, s55, 3
  v_xor_b32 v9, s56, v8
  v_lshl_add_u32 v24, v9, 5, v7
  v_mov_b32 v52, 0
  v_mov_b32 v53, 0
  v_mov_b32 v54, 0
  v_mov_b32 v55, 0
  v_mov_b32 v56, 0
  v_mov_b32 v57, 0
  v_mov_b32 v58, 0
  v_mov_b32 v59, 0
  v_mov_b32 v60, 0
  v_mov_b32 v61, 0
  v_mov_b32 v62, 0
  v_mov_b32 v63, 0
  v_mov_b32 v64, 0
  v_mov_b32 v65, 0
  v_mov_b32 v66, 0
  v_mov_b32 v67, 0
  v_mov_b32 v68, 0
  v_mov_b32 v69, 0
  v_mov_b32 v70, 0
  v_mov_b32 v71, 0
  v_mov_b32 v72, 0
  v_mov_b32 v73, 0
  v_mov_b32 v74, 0
  v_mov_b32 v75, 0
  v_mov_b32 v76, 0
  v_mov_b32 v77, 0
  v_mov_b32 v78, 0
  v_mov_b32 v79, 0
  v_mov_b32 v80, 0
  v_mov_b32 v81, 0
  v_mov_b32 v82, 0
  v_mov_b32 v83, 0
  v_mov_b32 v84, 0
  v_mov_b32 v85, 0
  v_mov_b32 v86, 0
  v_mov_b32 v87, 0
  v_mov_b32 v88, 0
  v_mov_b32 v89, 0
  v_mov_b32 v90, 0
  v_mov_b32 v91, 0
  v_mov_b32 v92, 0
  v_mov_b32 v93, 0
  v_mov_b32 v94, 0
  v_mov_b32 v95, 0
  v_mov_b32 v96, 0
  v_mov_b32 v97, 0
  v_mov_b32 v98, 0
  v_mov_b32 v99, 0
  v_mov_b32 v100, 0
  v_mov_b32 v101, 0
  v_mov_b32 v102, 0
  v_mov_b32 v103, 0
  v_mov_b32 v104, 0
  v_mov_b32 v105, 0
  v_mov_b32 v106, 0
  v_mov_b32 v107, 0
  v_mov_b32 v108, 0
  v_mov_b32 v109, 0
  v_mov_b32 v110, 0
  v_mov_b32 v111, 0
  v_mov_b32 v112, 0
  v_mov_b32 v113, 0
  v_mov_b32 v114, 0
  v_mov_b32 v115, 0
  v_mov_b32 v116, 0
  v_mov_b32 v117, 0
  v_mov_b32 v118, 0
  v_mov_b32 v119, 0
  v_mov_b32 v120, 0
  v_mov_b32 v121, 0
  v_mov_b32 v122, 0
  v_mov_b32 v123, 0
  v_mov_b32 v124, 0
  v_mov_b32 v125, 0
  v_mov_b32 v126, 0
  v_mov_b32 v127, 0
  v_mov_b32 v128, 0
  v_mov_b32 v129, 0
  v_mov_b32 v130, 0
  v_mov_b32 v131, 0
  v_mov_b32 v132, 0
  v_mov_b32 v133, 0
  v_mov_b32 v134, 0
  v_mov_b32 v135, 0
  v_mov_b32 v136, 0
  v_mov_b32 v137, 0
  v_mov_b32 v138, 0
  v_mov_b32 v139, 0
  v_mov_b32 v140, 0
  v_mov_b32 v141, 0
  v_mov_b32 v142, 0
  v_mov_b32 v143, 0
  v_mov_b32 v144, 0
  v_mov_b32 v145, 0
  v_mov_b32 v146, 0
  v_mov_b32 v147, 0
  s_lshl_b32 s58, s40, 6
  s_lshl_b32 s59, s38, 2
  s_add_u32 s58, s58, s59
  s_lshl_b32 s59, s43, 1
  s_add_u32 s58, s58, s59
  s_mul_i32 s58, s58, 36
  s_mul_i32 s59, s39, 12
  s_add_u32 s58, s58, s59
  s_mul_i32 s59, s44, 6
  s_add_u32 s58, s58, s59
  s_lshl_b32 s58, s58, 10
  s_add_u32 s59, s58, 36864
  v_lshlrev_b32 v36, 4, v1
  v_add_u32 v37, 4096, v36
  s_barrier
  ds_read_b64_tr_b16 v[148:149], v20 offset:0
  ds_read_b64_tr_b16 v[150:151], v20 offset:6144
  ds_read_b64_tr_b16 v[172:173], v21 offset:0
  ds_read_b64_tr_b16 v[174:175], v21 offset:4096
  ds_read_b64_tr_b16 v[176:177], v22 offset:0
  ds_read_b64_tr_b16 v[178:179], v22 offset:4096
  ds_read_b64_tr_b16 v[180:181], v23 offset:0
  ds_read_b64_tr_b16 v[182:183], v23 offset:4096
  ds_read_b64_tr_b16 v[184:185], v24 offset:0
  ds_read_b64_tr_b16 v[186:187], v24 offset:4096
  ds_read_b64_tr_b16 v[152:153], v20 offset:512
  ds_read_b64_tr_b16 v[154:155], v20 offset:6656
  ds_read_b64_tr_b16 v[156:157], v20 offset:1024
  ds_read_b64_tr_b16 v[158:159], v20 offset:7168
  ds_read_b64_tr_b16 v[160:161], v20 offset:1536
  ds_read_b64_tr_b16 v[162:163], v20 offset:7680
  ds_read_b64_tr_b16 v[164:165], v20 offset:2048
  ds_read_b64_tr_b16 v[166:167], v20 offset:8192
  ds_read_b64_tr_b16 v[168:169], v20 offset:2560
  ds_read_b64_tr_b16 v[170:171], v20 offset:8704
  s_mov_b32 s54, 40960
  s_mov_b32 s57, 0
  s_mov_b32 s56, 0
L2_loop:
  s_add_u32 s56, s56, 1
  s_cmp_eq_u32 s56, 3
  s_cselect_b32 s56, 0, s56
  s_cselect_b32 s55, 4294885376, s54
  s_waitcnt lgkmcnt(0)
  v_mfma_f32_16x16x32_bf16 v[52:55], v[148:151], v[172:175], v[52:55]
  ds_read_b64_tr_b16 v[188:189], v20 offset:12288
  ds_read_b64_tr_b16 v[190:191], v20 offset:18432
  v_mfma_f32_16x16x32_bf16 v[56:59], v[148:151], v[176:179], v[56:59]
  ds_read_b64_tr_b16 v[212:213], v21 offset:8192
  ds_read_b64_tr_b16 v[214:215], v21 offset:12288
  v_mfma_f32_16x16x32_bf16 v[60:63], v[148:151], v[180:183], v[60:63]
  ds_read_b64_tr_b16 v[216:217], v22 offset:8192
  ds_read_b64_tr_b16 v[218:219], v22 offset:12288
  v_mfma_f32_16x16x32_bf16 v[64:67], v[148:151], v[184:187], v[64:67]
  ds_read_b64_tr_b16 v[220:221], v23 offset:8192
  ds_read_b64_tr_b16 v[222:223], v23 offset:12288
  v_mfma_f32_16x16x32_bf16 v[68:71], v[152:155], v[172:175], v[68:71]
  ds_read_b64_tr_b16 v[224:225], v24 offset:8192
  ds_read_b64_tr_b16 v[226:227], v24 offset:12288
  v_mfma_f32_16x16x32_bf16 v[72:75], v[152:155], v[176:179], v[72:75]
  ds_read_b64_tr_b16 v[192:193], v20 offset:12800
  ds_read_b64_tr_b16 v[194:195], v20 offset:18944
  v_mfma_f32_16x16x32_bf16 v[76:79], v[152:155], v[180:183], v[76:79]
  ds_read_b64_tr_b16 v[196:197], v20 offset:13312
  ds_read_b64_tr_b16 v[198:199], v20 offset:19456
  v_mfma_f32_16x16x32_bf16 v[80:83], v[152:155], v[184:187], v[80:83]
  ds_read_b64_tr_b16 v[200:201], v20 offset:13824
  ds_read_b64_tr_b16 v[202:203], v20 offset:19968
  v_mfma_f32_16x16x32_bf16 v[84:87], v[156:159], v[172:175], v[84:87]
  ds_read_b64_tr_b16 v[204:205], v20 offset:14336
  ds_read_b64_tr_b16 v[206:207], v20 offset:20480
  v_mfma_f32_16x16x32_bf16 v[88:91], v[156:159], v[176:179], v[88:91]
  ds_read_b64_tr_b16 v[208:209], v20 offset:14848
  ds_read_b64_tr_b16 v[210:211], v20 offset:20992
  v_mfma_f32_16x16x32_bf16 v[92:95], v[156:159], v[180:183], v[92:95]
  v_add_u32 v20, s55, v20
  v_add_u32 v21, s55, v21
  v_mfma_f32_16x16x32_bf16 v[96:99], v[156:159], v[184:187], v[96:99]
  v_add_u32 v22, s55, v22
  v_add_u32 v23, s55, v23
  v_mfma_f32_16x16x32_bf16 v[100:103], v[160:163], v[172:175], v[100:103]
  v_add_u32 v24, s55, v24
  v_mfma_f32_16x16x32_bf16 v[104:107], v[160:163], v[176:179], v[104:107]
  v_mfma_f32_16x16x32_bf16 v[108:111], v[160:163], v[180:183], v[108:111]
  v_mfma_f32_16x16x32_bf16 v[112:115], v[160:163], v[184:187], v[112:115]
  v_mfma_f32_16x16x32_bf16 v[116:119], v[164:167], v[172:175], v[116:119]
  v_mfma_f32_16x16x32_bf16 v[120:123], v[164:167], v[176:179], v[120:123]
  v_mfma_f32_16x16x32_bf16 v[124:127], v[164:167], v[180:183], v[124:127]
  v_mfma_f32_16x16x32_bf16 v[128:131], v[164:167], v[184:187], v[128:131]
  v_mfma_f32_16x16x32_bf16 v[132:135], v[168:171], v[172:175], v[132:135]
  v_mfma_f32_16x16x32_bf16 v[136:139], v[168:171], v[176:179], v[136:139]
  v_mfma_f32_16x16x32_bf16 v[140:143], v[168:171], v[180:183], v[140:143]
  v_mfma_f32_16x16x32_bf16 v[144:147], v[168:171], v[184:187], v[144:147]
  s_waitcnt lgkmcnt(0)
  s_barrier
  v_mfma_f32_16x16x32_bf16 v[52:55], v[188:191], v[212:215], v[52:55]
  ds_read_b64_tr_b16 v[148:149], v20 offset:0
  ds_read_b64_tr_b16 v[150:151], v20 offset:6144
  v_mfma_f32_16x16x32_bf16 v[56:59], v[188:191], v[216:219], v[56:59]
  ds_read_b64_tr_b16 v[172:173], v21 offset:0
  ds_read_b64_tr_b16 v[174:175], v21 offset:4096
  v_mfma_f32_16x16x32_bf16 v[60:63], v[188:191], v[220:223], v[60:63]
  ds_read_b64_tr_b16 v[176:177], v22 offset:0
  ds_read_b64_tr_b16 v[178:179], v22 offset:4096
  v_mfma_f32_16x16x32_bf16 v[64:67], v[188:191], v[224:227], v[64:67]
  ds_read_b64_tr_b16 v[180:181], v23 offset:0
  ds_read_b64_tr_b16 v[182:183], v23 offset:4096
  v_mfma_f32_16x16x32_bf16 v[68:71], v[192:195], v[212:215], v[68:71]
  ds_read_b64_tr_b16 v[184:185], v24 offset:0
  ds_read_b64_tr_b16 v[186:187], v24 offset:4096
  v_mfma_f32_16x16x32_bf16 v[72:75], v[192:195], v[216:219], v[72:75]
  ds_read_b64_tr_b16 v[152:153], v20 offset:512
  ds_read_b64_tr_b16 v[154:155], v20 offset:6656
  v_mfma_f32_16x16x32_bf16 v[76:79], v[192:195], v[220:223], v[76:79]
  ds_read_b64_tr_b16 v[156:157], v20 offset:1024
  ds_read_b64_tr_b16 v[158:159], v20 offset:7168
  v_mfma_f32_16x16x32_bf16 v[80:83], v[192:195], v[224:227], v[80:83]
  ds_read_b64_tr_b16 v[160:161], v20 offset:1536
  ds_read_b64_tr_b16 v[162:163], v20 offset:7680
  v_mfma_f32_16x16x32_bf16 v[84:87], v[196:199], v[212:215], v[84:87]
  ds_read_b64_tr_b16 v[164:165], v20 offset:2048
  ds_read_b64_tr_b16 v[166:167], v20 offset:8192
  v_mfma_f32_16x16x32_bf16 v[88:91], v[196:199], v[216:219], v[88:91]
  ds_read_b64_tr_b16 v[168:169], v20 offset:2560
  ds_read_b64_tr_b16 v[170:171], v20 offset:8704
  v_mfma_f32_16x16x32_bf16 v[92:95], v[196:199], v[220:223], v[92:95]
  v_mfma_f32_16x16x32_bf16 v[96:99], v[196:199], v[224:227], v[96:99]
  v_mfma_f32_16x16x32_bf16 v[100:103], v[200:203], v[212:215], v[100:103]
  v_mfma_f32_16x16x32_bf16 v[104:107], v[200:203], v[216:219], v[104:107]
  v_mfma_f32_16x16x32_bf16 v[108:111], v[200:203], v[220:223], v[108:111]
  v_mfma_f32_16x16x32_bf16 v[112:115], v[200:203], v[224:227], v[112:115]
  v_mfma_f32_16x16x32_bf16 v[116:119], v[204:207], v[212:215], v[116:119]
  v_mfma_f32_16x16x32_bf16 v[120:123], v[204:207], v[216:219], v[120:123]
  v_mfma_f32_16x16x32_bf16 v[124:127], v[204:207], v[220:223], v[124:127]
  v_mfma_f32_16x16x32_bf16 v[128:131], v[204:207], v[224:227], v[128:131]
  v_mfma_f32_16x16x32_bf16 v[132:135], v[208:211], v[212:215], v[132:135]
  v_mfma_f32_16x16x32_bf16 v[136:139], v[208:211], v[216:219], v[136:139]
  v_mfma_f32_16x16x32_bf16 v[140:143], v[208:211], v[220:223], v[140:143]
  v_mfma_f32_16x16x32_bf16 v[144:147], v[208:211], v[224:227], v[144:147]
  s_add_u32 s57, s57, 1
  s_cmp_lt_u32 s57, 18
  s_cbranch_scc1 L2_loop
  v_cvt_pk_bf16_f32 v52, v52, v53
  v_cvt_pk_bf16_f32 v53, v54, v55
  v_cvt_pk_bf16_f32 v54, v56, v57
  v_cvt_pk_bf16_f32 v55, v58, v59
  buffer_store_dwordx4 v[52:55], v36, s[28:31], s58 offen offset:0 sc1
  v_cvt_pk_bf16_f32 v60, v60, v61
  v_cvt_pk_bf16_f32 v61, v62, v63
  v_cvt_pk_bf16_f32 v62, v64, v65
  v_cvt_pk_bf16_f32 v63, v66, v67
  buffer_store_dwordx4 v[60:63], v36, s[28:31], s59 offen offset:0 sc1
  v_cvt_pk_bf16_f32 v68, v68, v69
  v_cvt_pk_bf16_f32 v69, v70, v71
  v_cvt_pk_bf16_f32 v70, v72, v73
  v_cvt_pk_bf16_f32 v71, v74, v75
  buffer_store_dwordx4 v[68:71], v36, s[28:31], s58 offen offset:1024 sc1
  v_cvt_pk_bf16_f32 v76, v76, v77
  v_cvt_pk_bf16_f32 v77, v78, v79
  v_cvt_pk_bf16_f32 v78, v80, v81
  v_cvt_pk_bf16_f32 v79, v82, v83
  buffer_store_dwordx4 v[76:79], v36, s[28:31], s59 offen offset:1024 sc1
  v_cvt_pk_bf16_f32 v84, v84, v85
  v_cvt_pk_bf16_f32 v85, v86, v87
  v_cvt_pk_bf16_f32 v86, v88, v89
  v_cvt_pk_bf16_f32 v87, v90, v91
  buffer_store_dwordx4 v[84:87], v36, s[28:31], s58 offen offset:2048 sc1
  v_cvt_pk_bf16_f32 v92, v92, v93
  v_cvt_pk_bf16_f32 v93, v94, v95
  v_cvt_pk_bf16_f32 v94, v96, v97
  v_cvt_pk_bf16_f32 v95, v98, v99
  buffer_store_dwordx4 v[92:95], v36, s[28:31], s59 offen offset:2048 sc1
  v_cvt_pk_bf16_f32 v100, v100, v101
  v_cvt_pk_bf16_f32 v101, v102, v103
  v_cvt_pk_bf16_f32 v102, v104, v105
  v_cvt_pk_bf16_f32 v103, v106, v107
  buffer_store_dwordx4 v[100:103], v36, s[28:31], s58 offen offset:3072 sc1
  v_cvt_pk_bf16_f32 v108, v108, v109
  v_cvt_pk_bf16_f32 v109, v110, v111
  v_cvt_pk_bf16_f32 v110, v112, v113
  v_cvt_pk_bf16_f32 v111, v114, v115
  buffer_store_dwordx4 v[108:111], v36, s[28:31], s59 offen offset:3072 sc1
  v_cvt_pk_bf16_f32 v116, v116, v117
  v_cvt_pk_bf16_f32 v117, v118, v119
  v_cvt_pk_bf16_f32 v118, v120, v121
  v_cvt_pk_bf16_f32 v119, v122, v123
  buffer_store_dwordx4 v[116:119], v37, s[28:31], s58 offen offset:0 sc1
  v_cvt_pk_bf16_f32 v124, v124, v125
  v_cvt_pk_bf16_f32 v125, v126, v127
  v_cvt_pk_bf16_f32 v126, v128, v129
  v_cvt_pk_bf16_f32 v127, v130, v131
  buffer_store_dwordx4 v[124:127], v37, s[28:31], s59 offen offset:0 sc1
  v_cvt_pk_bf16_f32 v132, v132, v133
  v_cvt_pk_bf16_f32 v133, v134, v135
  v_cvt_pk_bf16_f32 v134, v136, v137
  v_cvt_pk_bf16_f32 v135, v138, v139
  buffer_store_dwordx4 v[132:135], v37, s[28:31], s58 offen offset:1024 sc1
  v_cvt_pk_bf16_f32 v140, v140, v141
  v_cvt_pk_bf16_f32 v141, v142, v143
  v_cvt_pk_bf16_f32 v142, v144, v145
  v_cvt_pk_bf16_f32 v143, v146, v147
  buffer_store_dwordx4 v[140:143], v37, s[28:31], s59 offen offset:1024 sc1
  s_endpgm
L2_attn:
  s_sub_u32 s36, s2, 192
  s_and_b32 s37, s36, 7
  s_lshl_b32 s37, s37, 2
  s_bfe_u32 s38, s36, 0x20003
  s_add_u32 s37, s37, s38
  s_lshr_b32 s38, s36, 5
  v_lshrrev_b32 v2, 6, v0
  v_and_b32 v1, 63, v0
  v_readfirstlane_b32 s18, v2
  v_lshrrev_b32 v2, 5, v1
  v_and_b32 v3, 31, v1
  s_lshl_b32 s48, s37, 6
  s_lshl_b32 s49, s38, 5
  s_add_u32 s48, s48, s49
  s_sub_u32 s48, s48, 8
  v_lshlrev_b32 v4, 4, v1
  s_add_u32 s49, s48, s18
  s_lshl_b32 s49, s49, 10
  v_add_u32 v5, s49, v4
  s_lshl_b32 s50, s18, 10
  s_mul_i32 s49, s48, 1152
  s_add_u32 s49, s49, s50
  v_add_u32 v6, s49, v4
  s_lshr_b32 s56, s37, 1
  s_lshl_b32 s56, s56, 6
  s_lshl_b32 s49, s38, 5
  s_add_u32 s56, s56, s49
  s_sub_u32 s56, s56, 8
  s_lshl_b32 s49, s56, 8
  s_add_u32 s49, s49, s50
  v_add_u32 v7, s49, v4
  s_and_b32 s59, s37, 1
  s_lshl_b32 s59, s59, 2
  s_waitcnt lgkmcnt(0)
  s_add_u32 s20, s8, 11534336
  s_addc_u32 s21, s9, 0
  s_mov_b32 s22, 2097152
  s_mov_b32 s23, 0x20000
  s_add_u32 s24, s8, 13893632
  s_addc_u32 s25, s9, 0
  s_mov_b32 s26, 262144
  s_mov_b32 s27, 0x20000
  s_add_u32 s28, s8, 14155776
  s_addc_u32 s29, s9, 0
  s_mov_b32 s30, 2359296
  s_mov_b32 s31, 0x20000
  s_add_u32 s32, s8, 9437184
  s_addc_u32 s33, s9, 0
  s_mov_b32 s34, 2097152
  s_mov_b32 s35, 0x20000
  s_add_u32 s40, s8, 13631488
  s_addc_u32 s41, s9, 0
  s_mov_b32 s42, 262144
  s_mov_b32 s43, 0x20000
  s_add_u32 s44, s8, 17825792
  s_addc_u32 s45, s9, 0
  s_mov_b32 s46, 2359296
  s_mov_b32 s47, 0x20000
  s_add_u32 m0, s50, 0
  v_add_u32 v8, 0, v5
  buffer_load_dwordx4 v8, s[20:23], 0 offen lds
  s_add_u32 m0, s50, 40960
  v_add_u32 v8, 0, v7
  buffer_load_dwordx4 v8, s[24:27], 0 offen lds
  s_add_u32 m0, s50, 8192
  v_add_u32 v8, 8192, v5
  buffer_load_dwordx4 v8, s[20:23], 0 offen lds
  s_add_u32 s51, s48, 8
  s_add_u32 s51, s51, s18
  s_lshl_b32 s52, s51, 10
  s_add_u32 s53, s56, 8
  s_add_u32 s53, s53, s18
  s_lshl_b32 s53, s53, 8
  s_add_u32 s53, s53, s59
  v_lshlrev_b32 v9, 3, v3
  v_mov_b32 v222, 0
  buffer_load_dwordx4 v[218:221], v4, s[32:35], s52 offen
  s_mov_b64 exec, 0xffffffff
  buffer_load_dword v222, v9, s[40:43], s53 offen
  s_mov_b64 exec, -1
  v_mov_b32 v243, v7
  s_add_u32 m0, s50, 57344
  v_add_u32 v8, 0, v6
  buffer_load_dwordx4 v8, s[28:31], 0 offen lds
  s_add_u32 m0, s50, 65536
  v_add_u32 v8, 8192, v6
  buffer_load_dwordx4 v8, s[28:31], 0 offen lds
  s_add_u32 m0, s50, 73728
  v_add_u32 v8, 16384, v6
  buffer_load_dwordx4 v8, s[28:31], 0 offen lds
  s_add_u32 m0, s50, 16384
  v_add_u32 v8, 16384, v5
  buffer_load_dwordx4 v8, s[20:23], 0 offen lds
  s_add_u32 m0, s50, 81920
  v_add_u32 v8, 24576, v6
  buffer_load_dwordx4 v8, s[28:31], 0 offen lds
  s_add_u32 m0, s50, 24576
  v_add_u32 v8, 24576, v5
  buffer_load_dwordx4 v8, s[20:23], 0 offen lds
  s_add_u32 m0, s50, 90112
  v_add_u32 v8, 32768, v6
  buffer_load_dwordx4 v8, s[28:31], 0 offen lds
  s_add_u32 m0, s50, 32768
  v_add_u32 v8, 32768, v5
  buffer_load_dwordx4 v8, s[20:23], 0 offen lds
  s_add_u32 m0, s50, 49152
  v_add_u32 v8, 8192, v243
  buffer_load_dwordx4 v8, s[24:27], 0 offen lds
  s_add_u32 m0, s50, 98304
  v_add_u32 v8, 40960, v6
  buffer_load_dwordx4 v8, s[28:31], 0 offen lds
  v_mov_b32 v200, 0
  v_mov_b32 v201, 0
  v_mov_b32 v161, 0
  v_mov_b32 v167, 0
  v_mov_b32 v173, 0
  v_mov_b32 v236, 0x3f803f80
  v_mov_b32 v237, 0x3f803f80
  v_mov_b32 v238, 0x3f803f80
  v_mov_b32 v239, 0x3f803f80
  v_min_u32 v10, 17, v1
  v_mul_u32_u24 v10, 576, v10
  v_add_u32 v10, 106496, v10
  ds_write_b128 v10, v[236:239]
  v_cmp_eq_u32 vcc, 0, v2
  v_mov_b32 v8, 0x3f80
  v_mov_b32 v234, 0
  v_mov_b32 v235, 0
  v_cndmask_b32 v236, 0, v236, vcc
  v_cndmask_b32 v237, 0, v8, vcc
  v_cndmask_b32 v199, 0, v8, vcc
  v_mov_b32 v238, 0
  v_mov_b32 v239, 0
  v_lshlrev_b32 v10, 3, v2
  v_sub_u32 v10, v3, v10
  v_cmp_le_i32 s[60:61], 0, v10
  v_cmp_le_i32 s[62:63], 1, v10
  v_cmp_le_i32 s[64:65], 2, v10
  v_cmp_le_i32 s[66:67], 3, v10
  v_cmp_le_i32 s[68:69], 4, v10
  v_cmp_le_i32 s[70:71], 5, v10
  v_cmp_le_i32 s[72:73], 6, v10
  v_cmp_le_i32 s[74:75], 7, v10
  v_cmp_le_i32 s[76:77], 16, v10
  v_cmp_le_i32 s[78:79], 17, v10
  v_cmp_le_i32 s[80:81], 18, v10
  v_cmp_le_i32 s[82:83], 19, v10
  v_cmp_le_i32 s[84:85], 20, v10
  v_cmp_le_i32 s[86:87], 21, v10
  v_cmp_le_i32 s[88:89], 22, v10
  v_cmp_le_i32 s[90:91], 23, v10
  v_mov_b32 v10, 0xffff
  v_mov_b32 v11, 0xffff0000
  v_cndmask_b32 v12, 0, v10, s[60:61]
  v_cndmask_b32 v13, 0, v11, s[62:63]
  v_or_b32 v224, v12, v13
  v_cndmask_b32 v12, 0, v10, s[64:65]
  v_cndmask_b32 v13, 0, v11, s[66:67]
  v_or_b32 v225, v12, v13
  v_cndmask_b32 v12, 0, v10, s[68:69]
  v_cndmask_b32 v13, 0, v11, s[70:71]
  v_or_b32 v226, v12, v13
  v_cndmask_b32 v12, 0, v10, s[72:73]
  v_cndmask_b32 v13, 0, v11, s[74:75]
  v_or_b32 v227, v12, v13
  v_cndmask_b32 v12, 0, v10, s[76:77]
  v_cndmask_b32 v13, 0, v11, s[78:79]
  v_or_b32 v228, v12, v13
  v_cndmask_b32 v12, 0, v10, s[80:81]
  v_cndmask_b32 v13, 0, v11, s[82:83]
  v_or_b32 v229, v12, v13
  v_cndmask_b32 v12, 0, v10, s[84:85]
  v_cndmask_b32 v13, 0, v11, s[86:87]
  v_or_b32 v230, v12, v13
  v_cndmask_b32 v12, 0, v10, s[88:89]
  v_cndmask_b32 v13, 0, v11, s[90:91]
  v_or_b32 v231, v12, v13
  v_add_u32 v11, s50, v4
  s_lshl_b32 s49, s18, 8
  s_add_u32 s49, s49, 40960
  s_add_u32 s49, s49, s59
  v_add_u32 v12, s49, v9
  s_mul_i32 s49, s18, 1152
  s_add_u32 s49, s49, 57344
  v_mul_u32_u24 v13, 288, v2
  v_lshl_add_u32 v13, v3, 4, v13
  v_add_u32 v13, s49, v13
  v_cmp_gt_u32 vcc, 18, v3
  v_mov_b32 v10, 106496
  v_mov_b32 v8, 9216
  s_mov_b32 s92, 0x07060302
  v_cndmask_b32 v13, v10, v13, vcc
  v_cndmask_b32 v240, 0, v8, vcc
  s_lshl_b32 s49, s38, 5
  s_add_u32 s49, s49, s18
  s_mul_i32 s49, s49, 36864
  s_lshl_b32 s56, s37, 10
  s_add_u32 s56, s56, s49
  v_add_u32 v14, s56, v4
  s_lshr_b32 s56, s37, 2
  s_lshl_b32 s56, s56, 9
  s_add_u32 s49, s49, s56
  s_and_b32 s56, s37, 3
  s_lshl_b32 s56, s56, 2
  s_add_u32 s49, s49, s56
  s_add_u32 s49, s49, 32768
  v_lshl_add_u32 v7, v3, 4, s49
  s_lshl_b32 s58, s38, 5
  s_add_u32 s58, s58, s18
  s_sub_i32 s58, 8, s58
  s_mov_b32 s57, 0
  s_waitcnt vmcnt(7) lgkmcnt(0)
  s_barrier
  s_branch L2_job0
L2_job:
  s_waitcnt vmcnt(2)
  s_cmp_lg_u32 s57, 1
  s_cbranch_scc1 L2_job0
  s_barrier
L2_job0:
  v_mov_b32 v194, v218
  v_mov_b32 v195, v219
  v_mov_b32 v196, v220
  v_mov_b32 v197, v221
  v_mov_b32 v198, v222
  ds_read_b128 v[162:165], v11 offset:8192
  ds_read_b32 v160, v12 offset:2048
  v_mov_b32 v161, 0
  ds_read_b128 v[168:171], v11 offset:0
  ds_read_b32 v166, v12 offset:0
  s_cmp_gt_i32 s58, 0
  s_cselect_b32 s93, 0xf149, 0
  v_mov_b32 v167, s93
  s_add_u32 s52, s52, 8192
  s_add_u32 s53, s53, 2048
  buffer_load_dwordx4 v[218:221], v4, s[32:35], s52 offen
  s_mov_b64 exec, 0xffffffff
  buffer_load_dword v222, v9, s[40:43], s53 offen
  s_mov_b64 exec, -1
  ds_read_b128 v[174:177], v11 offset:1024
  ds_read_b32 v172, v12 offset:256
  s_cmp_gt_i32 s58, 1
  s_cselect_b32 s93, 0xf149, 0
  v_mov_b32 v173, s93
  s_waitcnt lgkmcnt(4)
  v_mfma_f32_32x32x16_bf16 v[144:159], v[162:165], v[194:197], 0
  v_mfma_f32_32x32x16_bf16 v[144:159], v[160:163], v[198:201], v[144:159]
  ds_read_b128 v[162:165], v11 offset:2048
  ds_read_b32 v160, v12 offset:512
  s_cmp_gt_i32 s58, 2
  s_cselect_b32 s93, 0xf149, 0
  v_mov_b32 v161, s93
  s_waitcnt lgkmcnt(4)
  v_mfma_f32_32x32x16_bf16 v[16:31], v[168:171], v[194:197], 0
  v_mfma_f32_32x32x16_bf16 v[16:31], v[166:169], v[198:201], v[16:31]
  ds_read_b128 v[168:171], v11 offset:3072
  ds_read_b32 v166, v12 offset:768
  s_cmp_gt_i32 s58, 3
  s_cselect_b32 s93, 0xf149, 0
  v_mov_b32 v167, s93
  s_waitcnt lgkmcnt(4)
  v_mfma_f32_32x32x16_bf16 v[32:47], v[174:177], v[194:197], 0
  v_mfma_f32_32x32x16_bf16 v[32:47], v[172:175], v[198:201], v[32:47]
  ds_read_b128 v[174:177], v11 offset:4096
  ds_read_b32 v172, v12 offset:1024
  s_cmp_gt_i32 s58, 4
  s_cselect_b32 s93, 0xf149, 0
  v_mov_b32 v173, s93
  s_waitcnt lgkmcnt(4)
  v_mfma_f32_32x32x16_bf16 v[48:63], v[162:165], v[194:197], 0
  v_cndmask_b32 v16, v16, v144, s[60:61]
  v_cndmask_b32 v17, v17, v145, s[62:63]
  v_cndmask_b32 v18, v18, v146, s[64:65]
  v_cndmask_b32 v19, v19, v147, s[66:67]
  v_cndmask_b32 v20, v20, v148, s[68:69]
  v_cndmask_b32 v21, v21, v149, s[70:71]
  v_mfma_f32_32x32x16_bf16 v[48:63], v[160:163], v[198:201], v[48:63]
  v_cndmask_b32 v22, v22, v150, s[72:73]
  v_cndmask_b32 v23, v23, v151, s[74:75]
  v_cndmask_b32 v24, v24, v152, s[76:77]
  v_cndmask_b32 v25, v25, v153, s[78:79]
  v_cndmask_b32 v26, v26, v154, s[80:81]
  v_cndmask_b32 v27, v27, v155, s[82:83]
  ds_read_b128 v[162:165], v11 offset:5120
  ds_read_b32 v160, v12 offset:1280
  s_cmp_gt_i32 s58, 5
  s_cselect_b32 s93, 0xf149, 0
  v_mov_b32 v161, s93
  s_waitcnt lgkmcnt(4)
  v_mfma_f32_32x32x16_bf16 v[64:79], v[168:171], v[194:197], 0
  v_cndmask_b32 v28, v28, v156, s[84:85]
  v_cndmask_b32 v29, v29, v157, s[86:87]
  v_cndmask_b32 v30, v30, v158, s[88:89]
  v_cndmask_b32 v31, v31, v159, s[90:91]
  v_max3_f32 v202, v16, v17, v18
  v_mfma_f32_32x32x16_bf16 v[64:79], v[166:169], v[198:201], v[64:79]
  v_max3_f32 v203, v19, v20, v21
  v_max3_f32 v204, v22, v23, v24
  v_max3_f32 v205, v25, v26, v27
  v_max3_f32 v202, v202, v28, v29
  v_max3_f32 v203, v203, v30, v31
  ds_read_b128 v[168:171], v11 offset:6144
  ds_read_b32 v166, v12 offset:1536
  s_cmp_gt_i32 s58, 6
  s_cselect_b32 s93, 0xf149, 0
  v_mov_b32 v167, s93
  s_waitcnt lgkmcnt(4)
  v_mfma_f32_32x32x16_bf16 v[80:95], v[174:177], v[194:197], 0
  v_max3_f32 v202, v202, v32, v33
  v_max3_f32 v203, v203, v34, v35
  v_max3_f32 v204, v204, v36, v37
  v_max3_f32 v205, v205, v38, v39
  v_mfma_f32_32x32x16_bf16 v[80:95], v[172:175], v[198:201], v[80:95]
  v_max3_f32 v202, v202, v40, v41
  v_max3_f32 v203, v203, v42, v43
  v_max3_f32 v204, v204, v44, v45
  v_max3_f32 v205, v205, v46, v47
  ds_read_b128 v[174:177], v11 offset:7168
  ds_read_b32 v172, v12 offset:1792
  s_cmp_gt_i32 s58, 7
  s_cselect_b32 s93, 0xf149, 0
  v_mov_b32 v173, s93
  s_waitcnt lgkmcnt(4)
  v_mfma_f32_32x32x16_bf16 v[96:111], v[162:165], v[194:197], 0
  v_max3_f32 v202, v202, v48, v49
  v_max3_f32 v203, v203, v50, v51
  v_max3_f32 v204, v204, v52, v53
  v_max3_f32 v205, v205, v54, v55
  v_mfma_f32_32x32x16_bf16 v[96:111], v[160:163], v[198:201], v[96:111]
  v_max3_f32 v202, v202, v56, v57
  v_max3_f32 v203, v203, v58, v59
  v_max3_f32 v204, v204, v60, v61
  v_max3_f32 v205, v205, v62, v63
  s_waitcnt lgkmcnt(2)
  v_mfma_f32_32x32x16_bf16 v[112:127], v[168:171], v[194:197], 0
  v_max3_f32 v202, v202, v64, v65
  v_max3_f32 v203, v203, v66, v67
  v_max3_f32 v204, v204, v68, v69
  v_max3_f32 v205, v205, v70, v71
  v_mfma_f32_32x32x16_bf16 v[112:127], v[166:169], v[198:201], v[112:127]
  v_max3_f32 v202, v202, v72, v73
  v_max3_f32 v203, v203, v74, v75
  v_max3_f32 v204, v204, v76, v77
  v_max3_f32 v205, v205, v78, v79
  s_waitcnt lgkmcnt(0)
  v_mfma_f32_32x32x16_bf16 v[128:143], v[174:177], v[194:197], 0
  v_max3_f32 v202, v202, v80, v81
  v_max3_f32 v203, v203, v82, v83
  v_max3_f32 v204, v204, v84, v85
  v_max3_f32 v205, v205, v86, v87
  v_max3_f32 v202, v202, v88, v89
  v_max3_f32 v203, v203, v90, v91
  v_mfma_f32_32x32x16_bf16 v[128:143], v[172:175], v[198:201], v[128:143]
  v_max3_f32 v204, v204, v92, v93
  v_max3_f32 v205, v205, v94, v95
  v_max3_f32 v202, v202, v96, v97
  v_max3_f32 v203, v203, v98, v99
  v_max3_f32 v204, v204, v100, v101
  v_max3_f32 v205, v205, v102, v103
  ds_read_b128 v[178:181], v13 offset:1152
  ds_read_b128 v[182:185], v13 offset:1728
  ds_read_b128 v[186:189], v13 offset:2304
  ds_read_b128 v[190:193], v13 offset:2880
  v_max3_f32 v202, v202, v104, v105
  v_max3_f32 v203, v203, v106, v107
  v_max3_f32 v204, v204, v108, v109
  v_max3_f32 v205, v205, v110, v111
  v_max3_f32 v202, v202, v112, v113
  v_max3_f32 v203, v203, v114, v115
  v_max3_f32 v204, v204, v116, v117
  v_max3_f32 v205, v205, v118, v119
  v_max3_f32 v202, v202, v120, v121
  v_max3_f32 v203, v203, v122, v123
  v_max3_f32 v204, v204, v124, v125
  v_max3_f32 v205, v205, v126, v127
  v_max3_f32 v202, v202, v128, v129
  v_max3_f32 v203, v203, v130, v131
  v_max3_f32 v204, v204, v132, v133
  v_max3_f32 v205, v205, v134, v135
  v_max3_f32 v202, v202, v136, v137
  v_max3_f32 v203, v203, v138, v139
  v_max3_f32 v204, v204, v140, v141
  v_max3_f32 v205, v205, v142, v143
Lj_19:
  v_max_f32 v202, v202, v203
  v_max3_f32 v202, v202, v204, v205
  v_mov_b32 v203, v202
  s_nop 1
  v_permlane32_swap_b32 v202, v203
  s_nop 1
  v_min_f32 v202, -v202, -v203
  v_and_b32 v203, 0xffff0000, v202
  v_sub_f32 v204, v202, v203
  v_and_b32 v205, 0xffff0000, v204
  v_perm_b32 v232, v204, v202, s92
  v_sub_f32 v204, v204, v205
  v_lshrrev_b32 v233, 16, v204
  s_nop 1
  v_mfma_f32_32x32x16_bf16 v[32:47], v[236:239], v[232:235], v[32:47]
  v_mfma_f32_32x32x16_bf16 v[48:63], v[236:239], v[232:235], v[48:63]
  s_nop 7
  s_nop 3
  v_mfma_f32_32x32x16_bf16 v[64:79], v[236:239], v[232:235], v[64:79]
  v_exp_f32 v32, v32
  v_exp_f32 v33, v33
  v_exp_f32 v34, v34
  v_exp_f32 v35, v35
  v_exp_f32 v36, v36
  v_exp_f32 v37, v37
  v_exp_f32 v38, v38
  v_exp_f32 v39, v39
  v_cvt_pk_bf16_f32 v32, v32, v33
  v_cvt_pk_bf16_f32 v33, v34, v35
  v_cvt_pk_bf16_f32 v34, v36, v37
  v_cvt_pk_bf16_f32 v35, v38, v39
  v_exp_f32 v40, v40
  v_exp_f32 v41, v41
  v_exp_f32 v42, v42
  v_exp_f32 v43, v43
  s_waitcnt lgkmcnt(3)
  v_mfma_f32_32x32x16_bf16 v[202:217], v[178:181], v[32:35], 0
  ds_read_b128 v[178:181], v13 offset:3456
  v_exp_f32 v44, v44
  v_exp_f32 v45, v45
  v_exp_f32 v46, v46
  v_exp_f32 v47, v47
  v_cvt_pk_bf16_f32 v40, v40, v41
  v_cvt_pk_bf16_f32 v41, v42, v43
  v_cvt_pk_bf16_f32 v42, v44, v45
  v_cvt_pk_bf16_f32 v43, v46, v47
  v_mfma_f32_32x32x16_bf16 v[80:95], v[236:239], v[232:235], v[80:95]
  v_exp_f32 v48, v48
  v_exp_f32 v49, v49
  v_exp_f32 v50, v50
  v_exp_f32 v51, v51
  s_waitcnt lgkmcnt(3)
  v_mfma_f32_32x32x16_bf16 v[202:217], v[182:185], v[40:43], v[202:217]
  ds_read_b128 v[182:185], v13 offset:4032
  v_exp_f32 v52, v52
  v_exp_f32 v53, v53
  v_exp_f32 v54, v54
  v_exp_f32 v55, v55
  v_cvt_pk_bf16_f32 v48, v48, v49
  v_cvt_pk_bf16_f32 v49, v50, v51
  v_cvt_pk_bf16_f32 v50, v52, v53
  v_cvt_pk_bf16_f32 v51, v54, v55
  v_exp_f32 v56, v56
  v_exp_f32 v57, v57
  v_exp_f32 v58, v58
  v_exp_f32 v59, v59
  s_waitcnt lgkmcnt(3)
  v_mfma_f32_32x32x16_bf16 v[202:217], v[186:189], v[48:51], v[202:217]
  ds_read_b128 v[186:189], v13 offset:4608
  v_exp_f32 v60, v60
  v_exp_f32 v61, v61
  v_exp_f32 v62, v62
  v_exp_f32 v63, v63
  v_cvt_pk_bf16_f32 v56, v56, v57
  v_cvt_pk_bf16_f32 v57, v58, v59
  v_cvt_pk_bf16_f32 v58, v60, v61
  v_cvt_pk_bf16_f32 v59, v62, v63
  v_mfma_f32_32x32x16_bf16 v[96:111], v[236:239], v[232:235], v[96:111]
  v_exp_f32 v64, v64
  v_exp_f32 v65, v65
  v_exp_f32 v66, v66
  v_exp_f32 v67, v67
  s_waitcnt lgkmcnt(3)
  v_mfma_f32_32x32x16_bf16 v[202:217], v[190:193], v[56:59], v[202:217]
  ds_read_b128 v[190:193], v13 offset:5184
  v_exp_f32 v68, v68
  v_exp_f32 v69, v69
  v_exp_f32 v70, v70
  v_exp_f32 v71, v71
  v_cvt_pk_bf16_f32 v64, v64, v65
  v_cvt_pk_bf16_f32 v65, v66, v67
  v_cvt_pk_bf16_f32 v66, v68, v69
  v_cvt_pk_bf16_f32 v67, v70, v71
  v_exp_f32 v72, v72
  v_exp_f32 v73, v73
  v_exp_f32 v74, v74
  v_exp_f32 v75, v75
  s_waitcnt lgkmcnt(3)
  v_mfma_f32_32x32x16_bf16 v[202:217], v[178:181], v[64:67], v[202:217]
  ds_read_b128 v[178:181], v13 offset:5760
  v_exp_f32 v76, v76
  v_exp_f32 v77, v77
  v_exp_f32 v78, v78
  v_exp_f32 v79, v79
  v_cvt_pk_bf16_f32 v72, v72, v73
  v_cvt_pk_bf16_f32 v73, v74, v75
  v_cvt_pk_bf16_f32 v74, v76, v77
  v_cvt_pk_bf16_f32 v75, v78, v79
  v_mfma_f32_32x32x16_bf16 v[112:127], v[236:239], v[232:235], v[112:127]
  v_exp_f32 v80, v80
  v_exp_f32 v81, v81
  v_exp_f32 v82, v82
  v_exp_f32 v83, v83
  s_waitcnt lgkmcnt(3)
  v_mfma_f32_32x32x16_bf16 v[202:217], v[182:185], v[72:75], v[202:217]
  ds_read_b128 v[182:185], v13 offset:6336
  v_exp_f32 v84, v84
  v_exp_f32 v85, v85
  v_exp_f32 v86, v86
  v_exp_f32 v87, v87
  v_cvt_pk_bf16_f32 v80, v80, v81
  v_cvt_pk_bf16_f32 v81, v82, v83
  v_cvt_pk_bf16_f32 v82, v84, v85
  v_cvt_pk_bf16_f32 v83, v86, v87
  v_exp_f32 v88, v88
  v_exp_f32 v89, v89
  v_exp_f32 v90, v90
  v_exp_f32 v91, v91
  s_waitcnt lgkmcnt(3)
  v_mfma_f32_32x32x16_bf16 v[202:217], v[186:189], v[80:83], v[202:217]
  ds_read_b128 v[186:189], v13 offset:6912
  v_exp_f32 v92, v92
  v_exp_f32 v93, v93
  v_exp_f32 v94, v94
  v_exp_f32 v95, v95
  v_cvt_pk_bf16_f32 v88, v88, v89
  v_cvt_pk_bf16_f32 v89, v90, v91
  v_cvt_pk_bf16_f32 v90, v92, v93
  v_cvt_pk_bf16_f32 v91, v94, v95
  v_mfma_f32_32x32x16_bf16 v[128:143], v[236:239], v[232:235], v[128:143]
  v_exp_f32 v96, v96
  v_exp_f32 v97, v97
  v_exp_f32 v98, v98
  v_exp_f32 v99, v99
  s_waitcnt lgkmcnt(3)
  v_mfma_f32_32x32x16_bf16 v[202:217], v[190:193], v[88:91], v[202:217]
  ds_read_b128 v[190:193], v13 offset:7488
  v_exp_f32 v100, v100
  v_exp_f32 v101, v101
  v_exp_f32 v102, v102
  v_exp_f32 v103, v103
  v_cvt_pk_bf16_f32 v96, v96, v97
  v_cvt_pk_bf16_f32 v97, v98, v99
  v_cvt_pk_bf16_f32 v98, v100, v101
  v_cvt_pk_bf16_f32 v99, v102, v103
  v_exp_f32 v104, v104
  v_exp_f32 v105, v105
  v_exp_f32 v106, v106
  v_exp_f32 v107, v107
  s_waitcnt lgkmcnt(3)
  v_mfma_f32_32x32x16_bf16 v[202:217], v[178:181], v[96:99], v[202:217]
  ds_read_b128 v[178:181], v13 offset:8064
  v_exp_f32 v108, v108
  v_exp_f32 v109, v109
  v_exp_f32 v110, v110
  v_exp_f32 v111, v111
  v_cvt_pk_bf16_f32 v104, v104, v105
  v_cvt_pk_bf16_f32 v105, v106, v107
  v_cvt_pk_bf16_f32 v106, v108, v109
  v_cvt_pk_bf16_f32 v107, v110, v111
  v_mfma_f32_32x32x16_bf16 v[16:31], v[236:239], v[232:235], v[16:31]
  v_exp_f32 v112, v112
  v_exp_f32 v113, v113
  v_exp_f32 v114, v114
  v_exp_f32 v115, v115
  s_waitcnt lgkmcnt(3)
  v_mfma_f32_32x32x16_bf16 v[202:217], v[182:185], v[104:107], v[202:217]
  ds_read_b128 v[182:185], v13 offset:8640
  v_exp_f32 v116, v116
  v_exp_f32 v117, v117
  v_exp_f32 v118, v118
  v_exp_f32 v119, v119
  v_cvt_pk_bf16_f32 v112, v112, v113
  v_cvt_pk_bf16_f32 v113, v114, v115
  v_cvt_pk_bf16_f32 v114, v116, v117
  v_cvt_pk_bf16_f32 v115, v118, v119
  v_exp_f32 v120, v120
  v_exp_f32 v121, v121
  v_exp_f32 v122, v122
  v_exp_f32 v123, v123
  s_waitcnt lgkmcnt(3)
  v_mfma_f32_32x32x16_bf16 v[202:217], v[186:189], v[112:115], v[202:217]
  ds_read_b128 v[186:189], v13 offset:0
  v_exp_f32 v124, v124
  v_exp_f32 v125, v125
  v_exp_f32 v126, v126
  v_exp_f32 v127, v127
  v_cvt_pk_bf16_f32 v120, v120, v121
  v_cvt_pk_bf16_f32 v121, v122, v123
  v_cvt_pk_bf16_f32 v122, v124, v125
  v_cvt_pk_bf16_f32 v123, v126, v127
  v_exp_f32 v128, v128
  v_exp_f32 v129, v129
  v_exp_f32 v130, v130
  v_exp_f32 v131, v131
  s_waitcnt lgkmcnt(3)
  v_mfma_f32_32x32x16_bf16 v[202:217], v[190:193], v[120:123], v[202:217]
  ds_read_b128 v[190:193], v13 offset:9216
  v_exp_f32 v132, v132
  v_exp_f32 v133, v133
  v_exp_f32 v134, v134
  v_exp_f32 v135, v135
  v_cvt_pk_bf16_f32 v128, v128, v129
  v_cvt_pk_bf16_f32 v129, v130, v131
  v_cvt_pk_bf16_f32 v130, v132, v133
  v_cvt_pk_bf16_f32 v131, v134, v135
  v_exp_f32 v136, v136
  v_exp_f32 v137, v137
  v_exp_f32 v138, v138
  v_exp_f32 v139, v139
  s_waitcnt lgkmcnt(3)
  v_mfma_f32_32x32x16_bf16 v[202:217], v[178:181], v[128:131], v[202:217]
  ds_read_b128 v[178:181], v13 offset:576
  v_exp_f32 v140, v140
  v_exp_f32 v141, v141
  v_exp_f32 v142, v142
  v_exp_f32 v143, v143
  v_cvt_pk_bf16_f32 v136, v136, v137
  v_cvt_pk_bf16_f32 v137, v138, v139
  v_cvt_pk_bf16_f32 v138, v140, v141
  v_cvt_pk_bf16_f32 v139, v142, v143
  v_exp_f32 v16, v16
  v_exp_f32 v17, v17
  v_exp_f32 v18, v18
  v_exp_f32 v19, v19
  s_waitcnt lgkmcnt(3)
  v_mfma_f32_32x32x16_bf16 v[202:217], v[182:185], v[136:139], v[202:217]
  ds_read_b128 v[182:185], v13 offset:9792
  v_exp_f32 v20, v20
  v_exp_f32 v21, v21
  v_exp_f32 v22, v22
  v_exp_f32 v23, v23
  v_cvt_pk_bf16_f32 v16, v16, v17
  v_cvt_pk_bf16_f32 v17, v18, v19
  v_cvt_pk_bf16_f32 v18, v20, v21
  v_cvt_pk_bf16_f32 v19, v22, v23
  v_and_b32 v144, v224, v16
  v_and_b32 v145, v225, v17
  v_and_b32 v146, v226, v18
  v_and_b32 v147, v227, v19
  v_xor_b32 v16, v144, v16
  v_xor_b32 v17, v145, v17
  v_xor_b32 v18, v146, v18
  v_xor_b32 v19, v147, v19
  v_exp_f32 v24, v24
  v_exp_f32 v25, v25
  v_exp_f32 v26, v26
  v_exp_f32 v27, v27
  s_waitcnt lgkmcnt(3)
  v_mfma_f32_32x32x16_bf16 v[202:217], v[186:189], v[16:19], v[202:217]
  v_exp_f32 v28, v28
  v_exp_f32 v29, v29
  v_exp_f32 v30, v30
  v_exp_f32 v31, v31
  v_cvt_pk_bf16_f32 v24, v24, v25
  v_cvt_pk_bf16_f32 v25, v26, v27
  v_cvt_pk_bf16_f32 v26, v28, v29
  v_cvt_pk_bf16_f32 v27, v30, v31
  v_and_b32 v152, v228, v24
  v_and_b32 v153, v229, v25
  v_and_b32 v154, v230, v26
  v_and_b32 v155, v231, v27
  v_xor_b32 v24, v152, v24
  v_xor_b32 v25, v153, v25
  v_xor_b32 v26, v154, v26
  v_xor_b32 v27, v155, v27
  s_waitcnt lgkmcnt(2)
  v_mfma_f32_32x32x16_bf16 v[202:217], v[190:193], v[144:147], v[202:217]
  s_waitcnt lgkmcnt(1)
  v_mfma_f32_32x32x16_bf16 v[202:217], v[178:181], v[24:27], v[202:217]
  s_waitcnt lgkmcnt(0)
  v_mfma_f32_32x32x16_bf16 v[202:217], v[182:185], v[152:155], v[202:217]
  v_add_u32 v11, 8192, v11
  v_add_u32 v12, 2048, v12
  v_add_u32 v13, v240, v13
  s_sub_i32 s58, s58, 8
  s_add_u32 s57, s57, 1
  s_nop 7
  v_mov_b32 v10, v212
  v_mov_b32 v8, v212
  s_nop 1
  v_permlane32_swap_b32 v8, v10
  s_nop 1
  v_rcp_f32 v8, v8
  s_nop 0
  v_mul_f32 v202, v202, v8
  v_mul_f32 v203, v203, v8
  v_mul_f32 v204, v204, v8
  v_mul_f32 v205, v205, v8
  v_mul_f32 v206, v206, v8
  v_mul_f32 v207, v207, v8
  v_mul_f32 v208, v208, v8
  v_mul_f32 v209, v209, v8
  v_mul_f32 v210, v210, v8
  v_mul_f32 v211, v211, v8
  v_cvt_pk_bf16_f32 v16, v202, v203
  v_cvt_pk_bf16_f32 v17, v204, v205
  v_cvt_pk_bf16_f32 v18, v206, v207
  v_cvt_pk_bf16_f32 v19, v208, v209
  v_cvt_pk_bf16_f32 v20, v210, v211
  buffer_store_dwordx4 v[16:19], v14, s[44:47], 0 offen sc1
  s_mov_b64 exec, 0xffffffff
  buffer_store_dword v20, v7, s[44:47], 0 offen sc1
  s_mov_b64 exec, -1
  v_add_u32 v14, 294912, v14
  v_add_u32 v7, 294912, v7
  s_cmp_lt_u32 s57, 4
  s_cbranch_scc1 L2_job
L2_end:
  s_endpgm
  .globl k3_kernel
  .p2align 8
  .type k3_kernel,@function
k3_kernel:
  s_cmp_ge_u32 s2, 192
  s_cbranch_scc1 L3_end
  s_load_dwordx2 s[4:5], s[0:1], 0
  s_load_dwordx4 s[12:15], s[0:1], 56
  s_load_dwordx2 s[8:9], s[0:1], 80
  s_and_b32 s36, s2, 7
  s_lshr_b32 s37, s2, 3
  s_cmp_ge_u32 s37, 12
  s_cselect_b32 s38, 1, 0
  s_cselect_b32 s39, 12, 0
  s_sub_u32 s39, s37, s39
  s_lshl_b32 s36, s36, 1
  s_add_u32 s38, s38, s36
  v_lshrrev_b32 v2, 6, v0
  v_and_b32 v1, 63, v0
  v_readfirstlane_b32 s18, v2
  v_lshrrev_b32 v2, 4, v1
  v_and_b32 v3, 15, v1
  v_lshrrev_b32 v4, 2, v3
  v_and_b32 v5, 3, v3
  s_mul_i32 s41, s39, 55296
  s_mul_i32 s42, s18, 14336
  s_add_u32 s43, s41, s42
  v_lshlrev_b32 v10, 4, v1
  s_lshl_b32 s44, s38, 2
  s_add_u32 s44, s44, s18
  s_waitcnt lgkmcnt(0)
  s_add_u32 s20, s8, 8388608
  s_addc_u32 s21, s9, 0
  s_mov_b32 s22, 663552
  s_mov_b32 s23, 0x20000
  s_add_u32 s24, s8, 17825792
  s_addc_u32 s25, s9, 0
  s_mov_b32 s26, 2359296
  s_mov_b32 s27, 0x20000
  s_add_u32 s22, s41, 55296
  s_add_u32 m0, s42, 0
  s_add_u32 s45, s43, 0
  buffer_load_dwordx4 v10, s[20:23], s45 offen offset:0 lds
  buffer_load_dwordx4 v10, s[20:23], s45 offen offset:1024 lds
  buffer_load_dwordx4 v10, s[20:23], s45 offen offset:2048 lds
  buffer_load_dwordx4 v10, s[20:23], s45 offen offset:3072 lds
  s_add_u32 m0, s42, 4096
  s_add_u32 s45, s43, 4096
  buffer_load_dwordx4 v10, s[20:23], s45 offen offset:0 lds
  buffer_load_dwordx4 v10, s[20:23], s45 offen offset:1024 lds
  buffer_load_dwordx4 v10, s[20:23], s45 offen offset:2048 lds
  buffer_load_dwordx4 v10, s[20:23], s45 offen offset:3072 lds
  s_add_u32 m0, s42, 8192
  s_add_u32 s45, s43, 8192
  buffer_load_dwordx4 v10, s[20:23], s45 offen offset:0 lds
  buffer_load_dwordx4 v10, s[20:23], s45 offen offset:1024 lds
  buffer_load_dwordx4 v10, s[20:23], s45 offen offset:2048 lds
  buffer_load_dwordx4 v10, s[20:23], s45 offen offset:3072 lds
  s_add_u32 m0, s42, 12288
  s_add_u32 s45, s43, 12288
  buffer_load_dwordx4 v10, s[20:23], s45 offen offset:0 lds
  buffer_load_dwordx4 v10, s[20:23], s45 offen offset:1024 lds
  s_mul_i32 s45, s44, 36864
  v_lshlrev_b32 v6, 9, v2
  v_lshl_add_u32 v6, v3, 4, v6
  s_add_u32 s46, s45, 0
  buffer_load_dwordx4 a[0:3], v6, s[24:27], s46 offen offset:0
  buffer_load_dwordx4 a[4:7], v6, s[24:27], s46 offen offset:256
  buffer_load_dwordx4 a[8:11], v6, s[24:27], s46 offen offset:2048
  buffer_load_dwordx4 a[12:15], v6, s[24:27], s46 offen offset:2304
  s_add_u32 s46, s45, 4096
  buffer_load_dwordx4 a[16:19], v6, s[24:27], s46 offen offset:0
  buffer_load_dwordx4 a[20:23], v6, s[24:27], s46 offen offset:256
  buffer_load_dwordx4 a[24:27], v6, s[24:27], s46 offen offset:2048
  buffer_load_dwordx4 a[28:31], v6, s[24:27], s46 offen offset:2304
  s_add_u32 s46, s45, 8192
  buffer_load_dwordx4 a[32:35], v6, s[24:27], s46 offen offset:0
  buffer_load_dwordx4 a[36:39], v6, s[24:27], s46 offen offset:256
  buffer_load_dwordx4 a[40:43], v6, s[24:27], s46 offen offset:2048
  buffer_load_dwordx4 a[44:47], v6, s[24:27], s46 offen offset:2304
  s_add_u32 s46, s45, 12288
  buffer_load_dwordx4 a[48:51], v6, s[24:27], s46 offen offset:0
  buffer_load_dwordx4 a[52:55], v6, s[24:27], s46 offen offset:256
  buffer_load_dwordx4 a[56:59], v6, s[24:27], s46 offen offset:2048
  buffer_load_dwordx4 a[60:63], v6, s[24:27], s46 offen offset:2304
  s_add_u32 s46, s45, 16384
  buffer_load_dwordx4 a[64:67], v6, s[24:27], s46 offen offset:0
  buffer_load_dwordx4 a[68:71], v6, s[24:27], s46 offen offset:256
  buffer_load_dwordx4 a[72:75], v6, s[24:27], s46 offen offset:2048
  buffer_load_dwordx4 a[76:79], v6, s[24:27], s46 offen offset:2304
  s_add_u32 s46, s45, 20480
  buffer_load_dwordx4 a[80:83], v6, s[24:27], s46 offen offset:0
  buffer_load_dwordx4 a[84:87], v6, s[24:27], s46 offen offset:256
  buffer_load_dwordx4 a[88:91], v6, s[24:27], s46 offen offset:2048
  buffer_load_dwordx4 a[92:95], v6, s[24:27], s46 offen offset:2304
  s_add_u32 s46, s45, 24576
  buffer_load_dwordx4 a[96:99], v6, s[24:27], s46 offen offset:0
  buffer_load_dwordx4 a[100:103], v6, s[24:27], s46 offen offset:256
  buffer_load_dwordx4 a[104:107], v6, s[24:27], s46 offen offset:2048
  buffer_load_dwordx4 a[108:111], v6, s[24:27], s46 offen offset:2304
  s_add_u32 s46, s45, 28672
  buffer_load_dwordx4 a[112:115], v6, s[24:27], s46 offen offset:0
  buffer_load_dwordx4 a[116:119], v6, s[24:27], s46 offen offset:256
  buffer_load_dwordx4 a[120:123], v6, s[24:27], s46 offen offset:2048
  buffer_load_dwordx4 a[124:127], v6, s[24:27], s46 offen offset:2304
  s_add_u32 s46, s45, 32768
  buffer_load_dwordx4 a[128:131], v6, s[24:27], s46 offen offset:0
  buffer_load_dwordx4 a[132:135], v6, s[24:27], s46 offen offset:256
  buffer_load_dwordx4 a[136:139], v6, s[24:27], s46 offen offset:2048
  buffer_load_dwordx4 a[140:143], v6, s[24:27], s46 offen offset:2304
  s_add_u32 s28, s8, 27262976
  s_addc_u32 s29, s9, 0
  s_mov_b32 s30, 9437184
  s_mov_b32 s31, 0x20000
  s_mov_b32 s32, s4
  s_mov_b32 s33, s5
  s_mov_b32 s34, 2359296
  s_mov_b32 s35, 0x20000
  s_mov_b32 s48, s14
  s_mov_b32 s49, s15
  s_mov_b32 s50, 2359296
  s_mov_b32 s51, 0x20000
  s_mov_b32 s52, s12
  s_mov_b32 s53, s13
  s_mov_b32 s54, 4096
  s_mov_b32 s55, 0x20000
  s_mul_i32 s46, s44, 36
  s_mul_i32 s47, s39, 3
  s_add_u32 s46, s46, s47
  s_lshl_b32 s46, s46, 10
  buffer_load_dwordx4 v[72:75], v10, s[28:31], s46 offen offset:0
  buffer_load_dwordx4 v[76:79], v10, s[28:31], s46 offen offset:1024
  buffer_load_dwordx4 v[80:83], v10, s[28:31], s46 offen offset:2048
  s_add_u32 s46, s46, 2359296
  buffer_load_dwordx4 v[84:87], v10, s[28:31], s46 offen offset:0
  buffer_load_dwordx4 v[88:91], v10, s[28:31], s46 offen offset:1024
  buffer_load_dwordx4 v[92:95], v10, s[28:31], s46 offen offset:2048
  s_add_u32 s46, s46, 2359296
  buffer_load_dwordx4 v[96:99], v10, s[28:31], s46 offen offset:0
  buffer_load_dwordx4 v[100:103], v10, s[28:31], s46 offen offset:1024
  buffer_load_dwordx4 v[104:107], v10, s[28:31], s46 offen offset:2048
  s_add_u32 s46, s46, 2359296
  buffer_load_dwordx4 v[108:111], v10, s[28:31], s46 offen offset:0
  buffer_load_dwordx4 v[112:115], v10, s[28:31], s46 offen offset:1024
  buffer_load_dwordx4 v[116:119], v10, s[28:31], s46 offen offset:2048
  s_lshl_b32 s56, s44, 5
  s_mul_i32 s57, s39, 96
  s_mul_i32 s58, s18, 6656
  s_add_u32 s58, s58, 57344
  v_add_u32 v6, 0, v1
  v_mul_u32_u24 v7, 10923, v6
  v_lshrrev_b32 v7, 16, v7
  v_mul_u32_u24 v8, 6, v7
  v_sub_u32 v8, v6, v8
  v_mul_u32_u24 v9, 208, v7
  v_lshl_add_u32 v9, v8, 5, v9
  v_add_u32 v14, s58, v9
  v_add_u32 v7, s56, v7
  v_lshlrev_b32 v17, 1, v7
  v_mul_u32_u24 v7, 1152, v7
  v_lshl_add_u32 v7, v8, 4, v7
  v_add_u32 v11, s57, v7
  v_add_u32 v6, 64, v1
  v_mul_u32_u24 v7, 10923, v6
  v_lshrrev_b32 v7, 16, v7
  v_mul_u32_u24 v8, 6, v7
  v_sub_u32 v8, v6, v8
  v_mul_u32_u24 v9, 208, v7
  v_lshl_add_u32 v9, v8, 5, v9
  v_add_u32 v15, s58, v9
  v_add_u32 v7, s56, v7
  v_lshlrev_b32 v18, 1, v7
  v_mul_u32_u24 v7, 1152, v7
  v_lshl_add_u32 v7, v8, 4, v7
  v_add_u32 v12, s57, v7
  v_add_u32 v6, 128, v1
  v_mul_u32_u24 v7, 10923, v6
  v_lshrrev_b32 v7, 16, v7
  v_mul_u32_u24 v8, 6, v7
  v_sub_u32 v8, v6, v8
  v_mul_u32_u24 v9, 208, v7
  v_lshl_add_u32 v9, v8, 5, v9
  v_add_u32 v16, s58, v9
  v_add_u32 v7, s56, v7
  v_lshlrev_b32 v19, 1, v7
  v_mul_u32_u24 v7, 1152, v7
  v_lshl_add_u32 v7, v8, 4, v7
  v_add_u32 v13, s57, v7
  v_mul_u32_u24 v6, 208, v3
  v_lshl_add_u32 v6, v2, 4, v6
  v_add_u32 v21, s58, v6
  v_lshrrev_b32 v6, 1, v2
  v_lshlrev_b32 v6, 4, v6
  v_and_b32 v7, 1, v2
  v_lshl_add_u32 v6, v7, 2, v6
  v_add_u32 v6, v6, v4
  v_mul_u32_u24 v6, 96, v6
  v_lshl_add_u32 v20, v5, 3, v6
  s_waitcnt vmcnt(48)
  s_barrier
  ds_read_b64_tr_b16 v[48:49], v20 offset:0
  ds_read_b64_tr_b16 v[50:51], v20 offset:768
  ds_read_b64_tr_b16 v[52:53], v20 offset:32
  ds_read_b64_tr_b16 v[54:55], v20 offset:800
  ds_read_b64_tr_b16 v[56:57], v20 offset:64
  ds_read_b64_tr_b16 v[58:59], v20 offset:832
  s_waitcnt vmcnt(46) lgkmcnt(0)
  v_mfma_f32_16x16x32_bf16 v[24:27], v[48:51], a[0:3], 0
  ds_read_b64_tr_b16 v[60:61], v20 offset:3072
  ds_read_b64_tr_b16 v[62:63], v20 offset:3840
  v_mfma_f32_16x16x32_bf16 v[28:31], v[48:51], a[4:7], 0
  ds_read_b64_tr_b16 v[64:65], v20 offset:3104
  ds_read_b64_tr_b16 v[66:67], v20 offset:3872
  v_mfma_f32_16x16x32_bf16 v[32:35], v[52:55], a[0:3], 0
  ds_read_b64_tr_b16 v[68:69], v20 offset:3136
  ds_read_b64_tr_b16 v[70:71], v20 offset:3904
  v_mfma_f32_16x16x32_bf16 v[36:39], v[52:55], a[4:7], 0
  buffer_load_dwordx4 v[120:123], v11, s[32:35], 0 offen
  v_mfma_f32_16x16x32_bf16 v[40:43], v[56:59], a[0:3], 0
  v_mfma_f32_16x16x32_bf16 v[44:47], v[56:59], a[4:7], 0
  s_waitcnt vmcnt(45) lgkmcnt(0)
  v_mfma_f32_16x16x32_bf16 v[24:27], v[60:63], a[8:11], v[24:27]
  ds_read_b64_tr_b16 v[48:49], v20 offset:6144
  ds_read_b64_tr_b16 v[50:51], v20 offset:6912
  v_mfma_f32_16x16x32_bf16 v[28:31], v[60:63], a[12:15], v[28:31]
  ds_read_b64_tr_b16 v[52:53], v20 offset:6176
  ds_read_b64_tr_b16 v[54:55], v20 offset:6944
  v_mfma_f32_16x16x32_bf16 v[32:35], v[64:67], a[8:11], v[32:35]
  ds_read_b64_tr_b16 v[56:57], v20 offset:6208
  ds_read_b64_tr_b16 v[58:59], v20 offset:6976
  v_mfma_f32_16x16x32_bf16 v[36:39], v[64:67], a[12:15], v[36:39]
  buffer_load_dwordx4 v[124:127], v12, s[32:35], 0 offen
  v_mfma_f32_16x16x32_bf16 v[40:43], v[68:71], a[8:11], v[40:43]
  v_mfma_f32_16x16x32_bf16 v[44:47], v[68:71], a[12:15], v[44:47]
  s_waitcnt vmcnt(44) lgkmcnt(0)
  v_mfma_f32_16x16x32_bf16 v[24:27], v[48:51], a[16:19], v[24:27]
  ds_read_b64_tr_b16 v[60:61], v20 offset:9216
  ds_read_b64_tr_b16 v[62:63], v20 offset:9984
  v_mfma_f32_16x16x32_bf16 v[28:31], v[48:51], a[20:23], v[28:31]
  ds_read_b64_tr_b16 v[64:65], v20 offset:9248
  ds_read_b64_tr_b16 v[66:67], v20 offset:10016
  v_mfma_f32_16x16x32_bf16 v[32:35], v[52:55], a[16:19], v[32:35]
  ds_read_b64_tr_b16 v[68:69], v20 offset:9280
  ds_read_b64_tr_b16 v[70:71], v20 offset:10048
  v_mfma_f32_16x16x32_bf16 v[36:39], v[52:55], a[20:23], v[36:39]
  buffer_load_dwordx4 v[128:131], v13, s[32:35], 0 offen
  v_mfma_f32_16x16x32_bf16 v[40:43], v[56:59], a[16:19], v[40:43]
  v_mfma_f32_16x16x32_bf16 v[44:47], v[56:59], a[20:23], v[44:47]
  s_waitcnt vmcnt(43) lgkmcnt(0)
  v_mfma_f32_16x16x32_bf16 v[24:27], v[60:63], a[24:27], v[24:27]
  ds_read_b64_tr_b16 v[48:49], v20 offset:12288
  ds_read_b64_tr_b16 v[50:51], v20 offset:13056
  v_mfma_f32_16x16x32_bf16 v[28:31], v[60:63], a[28:31], v[28:31]
  ds_read_b64_tr_b16 v[52:53], v20 offset:12320
  ds_read_b64_tr_b16 v[54:55], v20 offset:13088
  v_mfma_f32_16x16x32_bf16 v[32:35], v[64:67], a[24:27], v[32:35]
  ds_read_b64_tr_b16 v[56:57], v20 offset:12352
  ds_read_b64_tr_b16 v[58:59], v20 offset:13120
  v_mfma_f32_16x16x32_bf16 v[36:39], v[64:67], a[28:31], v[36:39]
  buffer_load_short_d16_hi v132, v17, s[52:55], 0 offen
  v_mfma_f32_16x16x32_bf16 v[40:43], v[68:71], a[24:27], v[40:43]
  v_mfma_f32_16x16x32_bf16 v[44:47], v[68:71], a[28:31], v[44:47]
  s_waitcnt vmcnt(42) lgkmcnt(0)
  v_mfma_f32_16x16x32_bf16 v[24:27], v[48:51], a[32:35], v[24:27]
  ds_read_b64_tr_b16 v[60:61], v20 offset:15360
  ds_read_b64_tr_b16 v[62:63], v20 offset:16128
  v_mfma_f32_16x16x32_bf16 v[28:31], v[48:51], a[36:39], v[28:31]
  ds_read_b64_tr_b16 v[64:65], v20 offset:15392
  ds_read_b64_tr_b16 v[66:67], v20 offset:16160
  v_mfma_f32_16x16x32_bf16 v[32:35], v[52:55], a[32:35], v[32:35]
  ds_read_b64_tr_b16 v[68:69], v20 offset:15424
  ds_read_b64_tr_b16 v[70:71], v20 offset:16192
  v_mfma_f32_16x16x32_bf16 v[36:39], v[52:55], a[36:39], v[36:39]
  buffer_load_short_d16_hi v133, v18, s[52:55], 0 offen
  v_mfma_f32_16x16x32_bf16 v[40:43], v[56:59], a[32:35], v[40:43]
  v_mfma_f32_16x16x32_bf16 v[44:47], v[56:59], a[36:39], v[44:47]
  s_waitcnt vmcnt(41) lgkmcnt(0)
  v_mfma_f32_16x16x32_bf16 v[24:27], v[60:63], a[40:43], v[24:27]
  ds_read_b64_tr_b16 v[48:49], v20 offset:18432
  ds_read_b64_tr_b16 v[50:51], v20 offset:19200
  v_mfma_f32_16x16x32_bf16 v[28:31], v[60:63], a[44:47], v[28:31]
  ds_read_b64_tr_b16 v[52:53], v20 offset:18464
  ds_read_b64_tr_b16 v[54:55], v20 offset:19232
  v_mfma_f32_16x16x32_bf16 v[32:35], v[64:67], a[40:43], v[32:35]
  ds_read_b64_tr_b16 v[56:57], v20 offset:18496
  ds_read_b64_tr_b16 v[58:59], v20 offset:19264
  v_mfma_f32_16x16x32_bf16 v[36:39], v[64:67], a[44:47], v[36:39]
  buffer_load_short_d16_hi v134, v19, s[52:55], 0 offen
  v_mfma_f32_16x16x32_bf16 v[40:43], v[68:71], a[40:43], v[40:43]
  v_mfma_f32_16x16x32_bf16 v[44:47], v[68:71], a[44:47], v[44:47]
  s_waitcnt vmcnt(40) lgkmcnt(0)
  v_mfma_f32_16x16x32_bf16 v[24:27], v[48:51], a[48:51], v[24:27]
  ds_read_b64_tr_b16 v[60:61], v20 offset:21504
  ds_read_b64_tr_b16 v[62:63], v20 offset:22272
  v_mfma_f32_16x16x32_bf16 v[28:31], v[48:51], a[52:55], v[28:31]
  ds_read_b64_tr_b16 v[64:65], v20 offset:21536
  ds_read_b64_tr_b16 v[66:67], v20 offset:22304
  v_mfma_f32_16x16x32_bf16 v[32:35], v[52:55], a[48:51], v[32:35]
  ds_read_b64_tr_b16 v[68:69], v20 offset:21568
  ds_read_b64_tr_b16 v[70:71], v20 offset:22336
  v_mfma_f32_16x16x32_bf16 v[36:39], v[52:55], a[52:55], v[36:39]
  v_mfma_f32_16x16x32_bf16 v[40:43], v[56:59], a[48:51], v[40:43]
  v_mfma_f32_16x16x32_bf16 v[44:47], v[56:59], a[52:55], v[44:47]
  s_waitcnt vmcnt(38) lgkmcnt(0)
  v_mfma_f32_16x16x32_bf16 v[24:27], v[60:63], a[56:59], v[24:27]
  ds_read_b64_tr_b16 v[48:49], v20 offset:24576
  ds_read_b64_tr_b16 v[50:51], v20 offset:25344
  v_mfma_f32_16x16x32_bf16 v[28:31], v[60:63], a[60:63], v[28:31]
  ds_read_b64_tr_b16 v[52:53], v20 offset:24608
  ds_read_b64_tr_b16 v[54:55], v20 offset:25376
  v_mfma_f32_16x16x32_bf16 v[32:35], v[64:67], a[56:59], v[32:35]
  ds_read_b64_tr_b16 v[56:57], v20 offset:24640
  ds_read_b64_tr_b16 v[58:59], v20 offset:25408
  v_mfma_f32_16x16x32_bf16 v[36:39], v[64:67], a[60:63], v[36:39]
  v_mfma_f32_16x16x32_bf16 v[40:43], v[68:71], a[56:59], v[40:43]
  v_mfma_f32_16x16x32_bf16 v[44:47], v[68:71], a[60:63], v[44:47]
  s_waitcnt vmcnt(36) lgkmcnt(0)
  v_mfma_f32_16x16x32_bf16 v[24:27], v[48:51], a[64:67], v[24:27]
  ds_read_b64_tr_b16 v[60:61], v20 offset:27648
  ds_read_b64_tr_b16 v[62:63], v20 offset:28416
  v_mfma_f32_16x16x32_bf16 v[28:31], v[48:51], a[68:71], v[28:31]
  ds_read_b64_tr_b16 v[64:65], v20 offset:27680
  ds_read_b64_tr_b16 v[66:67], v20 offset:28448
  v_mfma_f32_16x16x32_bf16 v[32:35], v[52:55], a[64:67], v[32:35]
  ds_read_b64_tr_b16 v[68:69], v20 offset:27712
  ds_read_b64_tr_b16 v[70:71], v20 offset:28480
  v_mfma_f32_16x16x32_bf16 v[36:39], v[52:55], a[68:71], v[36:39]
  v_mfma_f32_16x16x32_bf16 v[40:43], v[56:59], a[64:67], v[40:43]
  v_mfma_f32_16x16x32_bf16 v[44:47], v[56:59], a[68:71], v[44:47]
  s_waitcnt vmcnt(34) lgkmcnt(0)
  v_mfma_f32_16x16x32_bf16 v[24:27], v[60:63], a[72:75], v[24:27]
  ds_read_b64_tr_b16 v[48:49], v20 offset:30720
  ds_read_b64_tr_b16 v[50:51], v20 offset:31488
  v_mfma_f32_16x16x32_bf16 v[28:31], v[60:63], a[76:79], v[28:31]
  ds_read_b64_tr_b16 v[52:53], v20 offset:30752
  ds_read_b64_tr_b16 v[54:55], v20 offset:31520
  v_mfma_f32_16x16x32_bf16 v[32:35], v[64:67], a[72:75], v[32:35]
  ds_read_b64_tr_b16 v[56:57], v20 offset:30784
  ds_read_b64_tr_b16 v[58:59], v20 offset:31552
  v_mfma_f32_16x16x32_bf16 v[36:39], v[64:67], a[76:79], v[36:39]
  v_mfma_f32_16x16x32_bf16 v[40:43], v[68:71], a[72:75], v[40:43]
  v_mfma_f32_16x16x32_bf16 v[44:47], v[68:71], a[76:79], v[44:47]
  s_waitcnt vmcnt(32) lgkmcnt(0)
  v_mfma_f32_16x16x32_bf16 v[24:27], v[48:51], a[80:83], v[24:27]
  ds_read_b64_tr_b16 v[60:61], v20 offset:33792
  ds_read_b64_tr_b16 v[62:63], v20 offset:34560
  v_mfma_f32_16x16x32_bf16 v[28:31], v[48:51], a[84:87], v[28:31]
  ds_read_b64_tr_b16 v[64:65], v20 offset:33824
  ds_read_b64_tr_b16 v[66:67], v20 offset:34592
  v_mfma_f32_16x16x32_bf16 v[32:35], v[52:55], a[80:83], v[32:35]
  ds_read_b64_tr_b16 v[68:69], v20 offset:33856
  ds_read_b64_tr_b16 v[70:71], v20 offset:34624
  v_mfma_f32_16x16x32_bf16 v[36:39], v[52:55], a[84:87], v[36:39]
  v_mfma_f32_16x16x32_bf16 v[40:43], v[56:59], a[80:83], v[40:43]
  v_mfma_f32_16x16x32_bf16 v[44:47], v[56:59], a[84:87], v[44:47]
  s_waitcnt vmcnt(30) lgkmcnt(0)
  v_mfma_f32_16x16x32_bf16 v[24:27], v[60:63], a[88:91], v[24:27]
  ds_read_b64_tr_b16 v[48:49], v20 offset:36864
  ds_read_b64_tr_b16 v[50:51], v20 offset:37632
  v_mfma_f32_16x16x32_bf16 v[28:31], v[60:63], a[92:95], v[28:31]
  ds_read_b64_tr_b16 v[52:53], v20 offset:36896
  ds_read_b64_tr_b16 v[54:55], v20 offset:37664
  v_mfma_f32_16x16x32_bf16 v[32:35], v[64:67], a[88:91], v[32:35]
  ds_read_b64_tr_b16 v[56:57], v20 offset:36928
  ds_read_b64_tr_b16 v[58:59], v20 offset:37696
  v_mfma_f32_16x16x32_bf16 v[36:39], v[64:67], a[92:95], v[36:39]
  v_mfma_f32_16x16x32_bf16 v[40:43], v[68:71], a[88:91], v[40:43]
  v_mfma_f32_16x16x32_bf16 v[44:47], v[68:71], a[92:95], v[44:47]
  s_waitcnt vmcnt(28) lgkmcnt(0)
  v_mfma_f32_16x16x32_bf16 v[24:27], v[48:51], a[96:99], v[24:27]
  ds_read_b64_tr_b16 v[60:61], v20 offset:39936
  ds_read_b64_tr_b16 v[62:63], v20 offset:40704
  v_mfma_f32_16x16x32_bf16 v[28:31], v[48:51], a[100:103], v[28:31]
  ds_read_b64_tr_b16 v[64:65], v20 offset:39968
  ds_read_b64_tr_b16 v[66:67], v20 offset:40736
  v_mfma_f32_16x16x32_bf16 v[32:35], v[52:55], a[96:99], v[32:35]
  ds_read_b64_tr_b16 v[68:69], v20 offset:40000
  ds_read_b64_tr_b16 v[70:71], v20 offset:40768
  v_mfma_f32_16x16x32_bf16 v[36:39], v[52:55], a[100:103], v[36:39]
  v_mfma_f32_16x16x32_bf16 v[40:43], v[56:59], a[96:99], v[40:43]
  v_mfma_f32_16x16x32_bf16 v[44:47], v[56:59], a[100:103], v[44:47]
  s_waitcnt vmcnt(26) lgkmcnt(0)
  v_mfma_f32_16x16x32_bf16 v[24:27], v[60:63], a[104:107], v[24:27]
  ds_read_b64_tr_b16 v[48:49], v20 offset:43008
  ds_read_b64_tr_b16 v[50:51], v20 offset:43776
  v_mfma_f32_16x16x32_bf16 v[28:31], v[60:63], a[108:111], v[28:31]
  ds_read_b64_tr_b16 v[52:53], v20 offset:43040
  ds_read_b64_tr_b16 v[54:55], v20 offset:43808
  v_mfma_f32_16x16x32_bf16 v[32:35], v[64:67], a[104:107], v[32:35]
  ds_read_b64_tr_b16 v[56:57], v20 offset:43072
  ds_read_b64_tr_b16 v[58:59], v20 offset:43840
  v_mfma_f32_16x16x32_bf16 v[36:39], v[64:67], a[108:111], v[36:39]
  v_mfma_f32_16x16x32_bf16 v[40:43], v[68:71], a[104:107], v[40:43]
  v_mfma_f32_16x16x32_bf16 v[44:47], v[68:71], a[108:111], v[44:47]
  s_waitcnt vmcnt(24) lgkmcnt(0)
  v_mfma_f32_16x16x32_bf16 v[24:27], v[48:51], a[112:115], v[24:27]
  ds_read_b64_tr_b16 v[60:61], v20 offset:46080
  ds_read_b64_tr_b16 v[62:63], v20 offset:46848
  v_mfma_f32_16x16x32_bf16 v[28:31], v[48:51], a[116:119], v[28:31]
  ds_read_b64_tr_b16 v[64:65], v20 offset:46112
  ds_read_b64_tr_b16 v[66:67], v20 offset:46880
  v_mfma_f32_16x16x32_bf16 v[32:35], v[52:55], a[112:115], v[32:35]
  ds_read_b64_tr_b16 v[68:69], v20 offset:46144
  ds_read_b64_tr_b16 v[70:71], v20 offset:46912
  v_mfma_f32_16x16x32_bf16 v[36:39], v[52:55], a[116:119], v[36:39]
  v_mfma_f32_16x16x32_bf16 v[40:43], v[56:59], a[112:115], v[40:43]
  v_mfma_f32_16x16x32_bf16 v[44:47], v[56:59], a[116:119], v[44:47]
  s_waitcnt vmcnt(22) lgkmcnt(0)
  v_mfma_f32_16x16x32_bf16 v[24:27], v[60:63], a[120:123], v[24:27]
  ds_read_b64_tr_b16 v[48:49], v20 offset:49152
  ds_read_b64_tr_b16 v[50:51], v20 offset:49920
  v_mfma_f32_16x16x32_bf16 v[28:31], v[60:63], a[124:127], v[28:31]
  ds_read_b64_tr_b16 v[52:53], v20 offset:49184
  ds_read_b64_tr_b16 v[54:55], v20 offset:49952
  v_mfma_f32_16x16x32_bf16 v[32:35], v[64:67], a[120:123], v[32:35]
  ds_read_b64_tr_b16 v[56:57], v20 offset:49216
  ds_read_b64_tr_b16 v[58:59], v20 offset:49984
  v_mfma_f32_16x16x32_bf16 v[36:39], v[64:67], a[124:127], v[36:39]
  v_mfma_f32_16x16x32_bf16 v[40:43], v[68:71], a[120:123], v[40:43]
  v_mfma_f32_16x16x32_bf16 v[44:47], v[68:71], a[124:127], v[44:47]
  s_waitcnt vmcnt(20) lgkmcnt(0)
  v_mfma_f32_16x16x32_bf16 v[24:27], v[48:51], a[128:131], v[24:27]
  ds_read_b64_tr_b16 v[60:61], v20 offset:52224
  ds_read_b64_tr_b16 v[62:63], v20 offset:52992
  v_mfma_f32_16x16x32_bf16 v[28:31], v[48:51], a[132:135], v[28:31]
  ds_read_b64_tr_b16 v[64:65], v20 offset:52256
  ds_read_b64_tr_b16 v[66:67], v20 offset:53024
  v_mfma_f32_16x16x32_bf16 v[32:35], v[52:55], a[128:131], v[32:35]
  ds_read_b64_tr_b16 v[68:69], v20 offset:52288
  ds_read_b64_tr_b16 v[70:71], v20 offset:53056
  v_mfma_f32_16x16x32_bf16 v[36:39], v[52:55], a[132:135], v[36:39]
  v_mfma_f32_16x16x32_bf16 v[40:43], v[56:59], a[128:131], v[40:43]
  v_mfma_f32_16x16x32_bf16 v[44:47], v[56:59], a[132:135], v[44:47]
  s_waitcnt vmcnt(18) lgkmcnt(0)
  v_mfma_f32_16x16x32_bf16 v[24:27], v[60:63], a[136:139], v[24:27]
  v_mfma_f32_16x16x32_bf16 v[28:31], v[60:63], a[140:143], v[28:31]
  v_mfma_f32_16x16x32_bf16 v[32:35], v[64:67], a[136:139], v[32:35]
  v_mfma_f32_16x16x32_bf16 v[36:39], v[64:67], a[140:143], v[36:39]
  v_mfma_f32_16x16x32_bf16 v[40:43], v[68:71], a[136:139], v[40:43]
  v_mfma_f32_16x16x32_bf16 v[44:47], v[68:71], a[140:143], v[44:47]
  s_waitcnt vmcnt(15)
  v_lshlrev_b32 v136, 16, v72
  v_and_b32 v137, 0xffff0000, v72
  v_lshlrev_b32 v138, 16, v73
  v_and_b32 v139, 0xffff0000, v73
  v_lshlrev_b32 v140, 16, v74
  v_and_b32 v141, 0xffff0000, v74
  v_lshlrev_b32 v142, 16, v75
  v_and_b32 v143, 0xffff0000, v75
  v_lshlrev_b32 v144, 16, v76
  v_and_b32 v145, 0xffff0000, v76
  v_lshlrev_b32 v146, 16, v77
  v_and_b32 v147, 0xffff0000, v77
  v_lshlrev_b32 v148, 16, v78
  v_and_b32 v149, 0xffff0000, v78
  v_lshlrev_b32 v150, 16, v79
  v_and_b32 v151, 0xffff0000, v79
  v_lshlrev_b32 v152, 16, v80
  v_and_b32 v153, 0xffff0000, v80
  v_lshlrev_b32 v154, 16, v81
  v_and_b32 v155, 0xffff0000, v81
  v_lshlrev_b32 v156, 16, v82
  v_and_b32 v157, 0xffff0000, v82
  v_lshlrev_b32 v158, 16, v83
  v_and_b32 v159, 0xffff0000, v83
  s_waitcnt vmcnt(12)
  v_lshlrev_b32 v160, 16, v84
  v_and_b32 v161, 0xffff0000, v84
  v_pk_add_f32 v[136:137], v[136:137], v[160:161]
  v_lshlrev_b32 v162, 16, v85
  v_and_b32 v163, 0xffff0000, v85
  v_pk_add_f32 v[138:139], v[138:139], v[162:163]
  v_lshlrev_b32 v164, 16, v86
  v_and_b32 v165, 0xffff0000, v86
  v_pk_add_f32 v[140:141], v[140:141], v[164:165]
  v_lshlrev_b32 v166, 16, v87
  v_and_b32 v167, 0xffff0000, v87
  v_pk_add_f32 v[142:143], v[142:143], v[166:167]
  v_lshlrev_b32 v160, 16, v88
  v_and_b32 v161, 0xffff0000, v88
  v_pk_add_f32 v[144:145], v[144:145], v[160:161]
  v_lshlrev_b32 v162, 16, v89
  v_and_b32 v163, 0xffff0000, v89
  v_pk_add_f32 v[146:147], v[146:147], v[162:163]
  v_lshlrev_b32 v164, 16, v90
  v_and_b32 v165, 0xffff0000, v90
  v_pk_add_f32 v[148:149], v[148:149], v[164:165]
  v_lshlrev_b32 v166, 16, v91
  v_and_b32 v167, 0xffff0000, v91
  v_pk_add_f32 v[150:151], v[150:151], v[166:167]
  v_lshlrev_b32 v160, 16, v92
  v_and_b32 v161, 0xffff0000, v92
  v_pk_add_f32 v[152:153], v[152:153], v[160:161]
  v_lshlrev_b32 v162, 16, v93
  v_and_b32 v163, 0xffff0000, v93
  v_pk_add_f32 v[154:155], v[154:155], v[162:163]
  v_lshlrev_b32 v164, 16, v94
  v_and_b32 v165, 0xffff0000, v94
  v_pk_add_f32 v[156:157], v[156:157], v[164:165]
  v_lshlrev_b32 v166, 16, v95
  v_and_b32 v167, 0xffff0000, v95
  v_pk_add_f32 v[158:159], v[158:159], v[166:167]
  s_waitcnt vmcnt(9)
  v_lshlrev_b32 v160, 16, v96
  v_and_b32 v161, 0xffff0000, v96
  v_pk_add_f32 v[136:137], v[136:137], v[160:161]
  v_lshlrev_b32 v162, 16, v97
  v_and_b32 v163, 0xffff0000, v97
  v_pk_add_f32 v[138:139], v[138:139], v[162:163]
  v_lshlrev_b32 v164, 16, v98
  v_and_b32 v165, 0xffff0000, v98
  v_pk_add_f32 v[140:141], v[140:141], v[164:165]
  v_lshlrev_b32 v166, 16, v99
  v_and_b32 v167, 0xffff0000, v99
  v_pk_add_f32 v[142:143], v[142:143], v[166:167]
  v_lshlrev_b32 v160, 16, v100
  v_and_b32 v161, 0xffff0000, v100
  v_pk_add_f32 v[144:145], v[144:145], v[160:161]
  v_lshlrev_b32 v162, 16, v101
  v_and_b32 v163, 0xffff0000, v101
  v_pk_add_f32 v[146:147], v[146:147], v[162:163]
  v_lshlrev_b32 v164, 16, v102
  v_and_b32 v165, 0xffff0000, v102
  v_pk_add_f32 v[148:149], v[148:149], v[164:165]
  v_lshlrev_b32 v166, 16, v103
  v_and_b32 v167, 0xffff0000, v103
  v_pk_add_f32 v[150:151], v[150:151], v[166:167]
  v_lshlrev_b32 v160, 16, v104
  v_and_b32 v161, 0xffff0000, v104
  v_pk_add_f32 v[152:153], v[152:153], v[160:161]
  v_lshlrev_b32 v162, 16, v105
  v_and_b32 v163, 0xffff0000, v105
  v_pk_add_f32 v[154:155], v[154:155], v[162:163]
  v_lshlrev_b32 v164, 16, v106
  v_and_b32 v165, 0xffff0000, v106
  v_pk_add_f32 v[156:157], v[156:157], v[164:165]
  v_lshlrev_b32 v166, 16, v107
  v_and_b32 v167, 0xffff0000, v107
  v_pk_add_f32 v[158:159], v[158:159], v[166:167]
  s_waitcnt vmcnt(6)
  v_lshlrev_b32 v160, 16, v108
  v_and_b32 v161, 0xffff0000, v108
  v_pk_add_f32 v[136:137], v[136:137], v[160:161]
  v_lshlrev_b32 v162, 16, v109
  v_and_b32 v163, 0xffff0000, v109
  v_pk_add_f32 v[138:139], v[138:139], v[162:163]
  v_lshlrev_b32 v164, 16, v110
  v_and_b32 v165, 0xffff0000, v110
  v_pk_add_f32 v[140:141], v[140:141], v[164:165]
  v_lshlrev_b32 v166, 16, v111
  v_and_b32 v167, 0xffff0000, v111
  v_pk_add_f32 v[142:143], v[142:143], v[166:167]
  v_lshlrev_b32 v160, 16, v112
  v_and_b32 v161, 0xffff0000, v112
  v_pk_add_f32 v[144:145], v[144:145], v[160:161]
  v_lshlrev_b32 v162, 16, v113
  v_and_b32 v163, 0xffff0000, v113
  v_pk_add_f32 v[146:147], v[146:147], v[162:163]
  v_lshlrev_b32 v164, 16, v114
  v_and_b32 v165, 0xffff0000, v114
  v_pk_add_f32 v[148:149], v[148:149], v[164:165]
  v_lshlrev_b32 v166, 16, v115
  v_and_b32 v167, 0xffff0000, v115
  v_pk_add_f32 v[150:151], v[150:151], v[166:167]
  v_lshlrev_b32 v160, 16, v116
  v_and_b32 v161, 0xffff0000, v116
  v_pk_add_f32 v[152:153], v[152:153], v[160:161]
  v_lshlrev_b32 v162, 16, v117
  v_and_b32 v163, 0xffff0000, v117
  v_pk_add_f32 v[154:155], v[154:155], v[162:163]
  v_lshlrev_b32 v164, 16, v118
  v_and_b32 v165, 0xffff0000, v118
  v_pk_add_f32 v[156:157], v[156:157], v[164:165]
  v_lshlrev_b32 v166, 16, v119
  v_and_b32 v167, 0xffff0000, v119
  v_pk_add_f32 v[158:159], v[158:159], v[166:167]
  v_pk_add_f32 v[136:137], v[136:137], v[24:25]
  v_pk_add_f32 v[138:139], v[138:139], v[26:27]
  ds_write_b128 v21, v[136:139] offset:0
  v_pk_add_f32 v[140:141], v[140:141], v[28:29]
  v_pk_add_f32 v[142:143], v[142:143], v[30:31]
  ds_write_b128 v21, v[140:143] offset:3328
  v_pk_add_f32 v[144:145], v[144:145], v[32:33]
  v_pk_add_f32 v[146:147], v[146:147], v[34:35]
  ds_write_b128 v21, v[144:147] offset:64
  v_pk_add_f32 v[148:149], v[148:149], v[36:37]
  v_pk_add_f32 v[150:151], v[150:151], v[38:39]
  ds_write_b128 v21, v[148:151] offset:3392
  v_pk_add_f32 v[152:153], v[152:153], v[40:41]
  v_pk_add_f32 v[154:155], v[154:155], v[42:43]
  ds_write_b128 v21, v[152:155] offset:128
  v_pk_add_f32 v[156:157], v[156:157], v[44:45]
  v_pk_add_f32 v[158:159], v[158:159], v[46:47]
  ds_write_b128 v21, v[156:159] offset:3456
  s_waitcnt lgkmcnt(0)
  ds_read_b128 v[72:75], v14
  ds_read_b128 v[76:79], v14 offset:16
  ds_read_b128 v[80:83], v15
  ds_read_b128 v[84:87], v15 offset:16
  ds_read_b128 v[88:91], v16
  ds_read_b128 v[92:95], v16 offset:16
  s_waitcnt vmcnt(0)
  v_and_b32 v168, 0xffff0000, v132
  v_lshlrev_b32 v136, 16, v120
  v_and_b32 v137, 0xffff0000, v120
  v_lshlrev_b32 v138, 16, v121
  v_and_b32 v139, 0xffff0000, v121
  v_lshlrev_b32 v140, 16, v122
  v_and_b32 v141, 0xffff0000, v122
  v_lshlrev_b32 v142, 16, v123
  v_and_b32 v143, 0xffff0000, v123
  v_pk_add_f32 v[136:137], v[136:137], v[168:169] op_sel_hi:[1,0]
  v_pk_add_f32 v[138:139], v[138:139], v[168:169] op_sel_hi:[1,0]
  v_pk_add_f32 v[140:141], v[140:141], v[168:169] op_sel_hi:[1,0]
  v_pk_add_f32 v[142:143], v[142:143], v[168:169] op_sel_hi:[1,0]
  v_and_b32 v170, 0xffff0000, v133
  v_lshlrev_b32 v144, 16, v124
  v_and_b32 v145, 0xffff0000, v124
  v_lshlrev_b32 v146, 16, v125
  v_and_b32 v147, 0xffff0000, v125
  v_lshlrev_b32 v148, 16, v126
  v_and_b32 v149, 0xffff0000, v126
  v_lshlrev_b32 v150, 16, v127
  v_and_b32 v151, 0xffff0000, v127
  v_pk_add_f32 v[144:145], v[144:145], v[170:171] op_sel_hi:[1,0]
  v_pk_add_f32 v[146:147], v[146:147], v[170:171] op_sel_hi:[1,0]
  v_pk_add_f32 v[148:149], v[148:149], v[170:171] op_sel_hi:[1,0]
  v_pk_add_f32 v[150:151], v[150:151], v[170:171] op_sel_hi:[1,0]
  v_and_b32 v172, 0xffff0000, v134
  v_lshlrev_b32 v152, 16, v128
  v_and_b32 v153, 0xffff0000, v128
  v_lshlrev_b32 v154, 16, v129
  v_and_b32 v155, 0xffff0000, v129
  v_lshlrev_b32 v156, 16, v130
  v_and_b32 v157, 0xffff0000, v130
  v_lshlrev_b32 v158, 16, v131
  v_and_b32 v159, 0xffff0000, v131
  v_pk_add_f32 v[152:153], v[152:153], v[172:173] op_sel_hi:[1,0]
  v_pk_add_f32 v[154:155], v[154:155], v[172:173] op_sel_hi:[1,0]
  v_pk_add_f32 v[156:157], v[156:157], v[172:173] op_sel_hi:[1,0]
  v_pk_add_f32 v[158:159], v[158:159], v[172:173] op_sel_hi:[1,0]
  s_waitcnt lgkmcnt(4)
  v_pk_add_f32 v[136:137], v[136:137], v[72:73]
  v_pk_add_f32 v[138:139], v[138:139], v[74:75]
  v_pk_add_f32 v[140:141], v[140:141], v[76:77]
  v_pk_add_f32 v[142:143], v[142:143], v[78:79]
  v_cvt_pk_bf16_f32 v136, v136, v137
  v_cvt_pk_bf16_f32 v137, v138, v139
  v_cvt_pk_bf16_f32 v138, v140, v141
  v_cvt_pk_bf16_f32 v139, v142, v143
  buffer_store_dwordx4 v[136:139], v11, s[48:51], 0 offen
  s_waitcnt lgkmcnt(2)
  v_pk_add_f32 v[144:145], v[144:145], v[80:81]
  v_pk_add_f32 v[146:147], v[146:147], v[82:83]
  v_pk_add_f32 v[148:149], v[148:149], v[84:85]
  v_pk_add_f32 v[150:151], v[150:151], v[86:87]
  v_cvt_pk_bf16_f32 v144, v144, v145
  v_cvt_pk_bf16_f32 v145, v146, v147
  v_cvt_pk_bf16_f32 v146, v148, v149
  v_cvt_pk_bf16_f32 v147, v150, v151
  buffer_store_dwordx4 v[144:147], v12, s[48:51], 0 offen
  s_waitcnt lgkmcnt(0)
  v_pk_add_f32 v[152:153], v[152:153], v[88:89]
  v_pk_add_f32 v[154:155], v[154:155], v[90:91]
  v_pk_add_f32 v[156:157], v[156:157], v[92:93]
  v_pk_add_f32 v[158:159], v[158:159], v[94:95]
  v_cvt_pk_bf16_f32 v152, v152, v153
  v_cvt_pk_bf16_f32 v153, v154, v155
  v_cvt_pk_bf16_f32 v154, v156, v157
  v_cvt_pk_bf16_f32 v155, v158, v159
  buffer_store_dwordx4 v[152:155], v13, s[48:51], 0 offen
L3_end:
  s_endpgm
.section .rodata,"a"
.p2align 6
.amdhsa_kernel k0_kernel
  .amdhsa_next_free_vgpr 116
  .amdhsa_next_free_sgpr 102
  .amdhsa_accum_offset 116
  .amdhsa_group_segment_fixed_size 0
  .amdhsa_kernarg_size 88
  .amdhsa_user_sgpr_count 2
  .amdhsa_user_sgpr_kernarg_segment_ptr 1
  .amdhsa_system_sgpr_workgroup_id_x 1
.end_amdhsa_kernel
.p2align 6
.amdhsa_kernel k1_kernel
  .amdhsa_next_free_vgpr 256
  .amdhsa_next_free_sgpr 102
  .amdhsa_accum_offset 256
  .amdhsa_group_segment_fixed_size 0
  .amdhsa_kernarg_size 88
  .amdhsa_user_sgpr_count 2
  .amdhsa_user_sgpr_kernarg_segment_ptr 1
  .amdhsa_system_sgpr_workgroup_id_x 1
.end_amdhsa_kernel
.p2align 6
.amdhsa_kernel k2_kernel
  .amdhsa_next_free_vgpr 244
  .amdhsa_next_free_sgpr 102
  .amdhsa_accum_offset 244
  .amdhsa_group_segment_fixed_size 0
  .amdhsa_kernarg_size 88
  .amdhsa_user_sgpr_count 2
  .amdhsa_user_sgpr_kernarg_segment_ptr 1
  .amdhsa_system_sgpr_workgroup_id_x 1
.end_amdhsa_kernel
.p2align 6
.amdhsa_kernel k3_kernel
  .amdhsa_next_free_vgpr 320
  .amdhsa_next_free_sgpr 102
  .amdhsa_accum_offset 176
  .amdhsa_group_segment_fixed_size 0
  .amdhsa_kernarg_size 88
  .amdhsa_user_sgpr_count 2
  .amdhsa_user_sgpr_kernarg_segment_ptr 1
  .amdhsa_system_sgpr_workgroup_id_x 1
.end_amdhsa_kernel
```
